```python
import torch

def _softmax(x, axis=-1):
    return torch.softmax(x, dim=axis)
def _gelu(x):
    return torch.nn.functional.gelu(x, approximate="tanh")
def _silu(x):
    return torch.nn.functional.silu(x)
def _sigmoid(x):
    return torch.sigmoid(x)
def _layernorm(x, axis=-1, eps=1e-5):
    m = x.mean(dim=axis, keepdim=True)
    v = x.var(dim=axis, keepdim=True, unbiased=False)
    return (x - m) / torch.sqrt(v + eps)
def _scatter_add(tgt, idx, src, axis=0):
    return tgt.clone().index_add_(axis, idx, src)
def _segment_sum(src, seg, n):
    out = torch.zeros((n,) + src.shape[1:], dtype=src.dtype)
    return out.index_add_(0, seg, src)
def _pad(x, pw):
    flat = tuple(v for pair in reversed(pw) for v in pair)
    return torch.nn.functional.pad(x, flat)

kernel_name = 'gated_mix__linear_attn_block__dense_activation_mish__prompt'

def setup_inputs():

    _w = (lambda a: (lambda t: t.to(torch.bfloat16) if t.is_floating_point() else t)(torch.as_tensor(a)))
    def _A_setup():
        B, S, D = 1, 2048, 448
        return {
            "x": _w((lambda *s: torch.randn(*s, dtype=torch.bfloat16) * 0.05)(B, S, D)),
            "wqkv": _w((lambda *s: torch.randn(*s, dtype=torch.bfloat16) * 0.8)(D, 3 * D)),
            "wo": _w((lambda *s: torch.randn(*s, dtype=torch.bfloat16) * 0.1)(D, D)),
        }
    _A_in = _A_setup()

    def _B_setup():
        B, S, D, F = 1, 2048, 448, 1792
        return {
            "x": _w((lambda *s: torch.randn(*s, dtype=torch.bfloat16) * 0.05)(B, S, D)),
            "w1": _w((lambda *s: torch.randn(*s, dtype=torch.bfloat16) * 12.8)(D, F) * (D ** -0.5)),
            "b1": _w((lambda *s: torch.randn(*s, dtype=torch.bfloat16) * 0.2)(F)),
            "w2": _w((lambda *s: torch.randn(*s, dtype=torch.bfloat16) * 0.05)(F, D) * (F ** -0.5)),
        }
    _B_in = _B_setup()

    return {
        "A_x": _A_in["x"],
        "A_wqkv": _A_in["wqkv"],
        "A_wo": _A_in["wo"],
        "B_x": _B_in["x"],
        "B_w1": _B_in["w1"],
        "B_b1": _B_in["b1"],
        "B_w2": _B_in["w2"],
        "gate_w": _w((lambda *s: torch.randn(*s, dtype=torch.bfloat16) * 0.05)(448) * 16.0),
    }

def reference(A_x, A_wqkv, A_wo, B_x, B_w1, B_b1, B_w2, gate_w):
    def _A_ref(x, wqkv, wo):
        B, S, D = x.shape
        H = 16; Dh = D // H
        qkv = (lambda x, *d: x.permute(*d))((x @ wqkv).reshape(B, S, 3, H, Dh), 2, 0, 3, 1, 4)
        q, k, v = qkv[0], qkv[1], qkv[2]
        phi = lambda t: torch.where(t > 0, t + 1, torch.exp(t)) + 1e-6
        pq, pk = phi(q), phi(k)
        kv = torch.einsum("bhsd,bhse->bhde", pk, v)
        z = torch.einsum("bhsd->bhd", pk)
        num = torch.einsum("bhqd,bhde->bhqe", pq, kv)
        den = torch.einsum("bhqd,bhd->bhq", pq, z)[..., None] + 1e-6
        o = num / den
        return (lambda x, *d: x.permute(*d))(o, 0, 2, 1, 3).reshape(B, S, D) @ wo

    def _B_ref(x, w1, b1, w2):
        h = torch.einsum("bsd,df->bsf", x, w1) + b1
        sp = torch.log1p(torch.exp(-torch.abs(h))) + torch.where(h > 0, h, torch.zeros_like(h))
        act = h * torch.tanh(sp)
        return torch.einsum("bsf,fd->bsd", act, w2)

    x = A_x
    g = _sigmoid((x * gate_w).sum(-1, keepdims=True))
    a = _A_ref(x, A_wqkv, A_wo)
    b = _B_ref(x, B_w1, B_b1, B_w2)
    return g * a + (1 - g) * b
```

```asm
; @launch grid=(256,1,1) block=(256,1,1) lds=163840
.amdgcn_target "amdgcn-amd-amdhsa--gfx950"
.text
.globl gated_mix__linear_attn_block__dense_activation_mish__prompt_kernel
.p2align 8
.type gated_mix__linear_attn_block__dense_activation_mish__prompt_kernel,@function
gated_mix__linear_attn_block__dense_activation_mish__prompt_kernel:
  s_cmp_ge_u32 s2, 256
  s_cbranch_scc1 L_end
  s_load_dwordx16 s[84:99], s[0:1], 0
  s_load_dwordx2 s[28:29], s[0:1], 80
  s_load_dwordx2 s[32:33], s[0:1], 64
  s_getpc_b64 s[4:5]
L_pc:
  s_bfe_u32 s3, s2, 0x30003
  s_lshl_b32 s3, s3, 6
  v_lshrrev_b32 v54, 6, v0
  v_and_or_b32 v3, v0, 15, s3
  v_lshl_add_u32 v2, v54, 4, v3
  v_lshlrev_b32 v2, 6, v2
  v_min_u32 v2, L_codeend-L_pc-4, v2
  v_add_co_u32 v2, vcc, s4, v2
  v_mov_b32 v3, s5
  v_and_b32 v1, 63, v0
  v_addc_co_u32 v3, vcc, 0, v3, vcc
  global_load_dword v222, v[2:3], off
  v_readfirstlane_b32 s46, v54
  s_bfe_u32 s54, s2, 0x20001
  s_bfe_u32 s55, s2, 0x20003
  s_lshl2_add_u32 s44, s54, s55
  s_and_b32 s51, s2, 1
  s_lshr_b32 s52, s2, 5
  s_lshl3_add_u32 s45, s51, s52
  s_mov_b32 s14, 1204224
  s_mov_b32 s15, 0x20000
  s_mov_b32 s10, 1835008
  s_mov_b32 s11, 0x20000
  s_lshl_b32 s65, s46, 12
  v_lshrrev_b32 v192, 3, v1
  v_and_b32 v193, 7, v1
  v_lshrrev_b32 v194, 4, v1
  v_lshrrev_b32 v195, 5, v1
  v_bfe_u32 v196, v1, 2, 2
  v_and_b32 v197, 3, v1
  v_and_b32 v198, 1, v194
  v_and_b32 v199, 15, v1
  v_lshl_add_u32 v200, v195, 2, v196
  v_lshl_add_u32 v200, v198, 3, v200
  v_mul_u32_u24 v200, 2688, v200
  v_lshlrev_b32 v201, 1, v198
  v_xor_b32 v201, v201, v197
  v_lshl_add_u32 v200, v201, 4, v200
  s_add_u32 s54, s46, 1
  s_mul_i32 s54, s54, 896
  s_cmp_eq_u32 s46, 2
  s_cselect_b32 s54, 0, s54
  s_cmp_eq_u32 s46, 3
  s_cselect_b32 s54, 0x40000000, s54
  s_mul_i32 s55, s44, 86016
  s_add_u32 s54, s54, s55
  s_mul_i32 s55, s45, 56
  s_add_u32 s54, s54, s55
  v_add_u32 v16, s54, v200
  s_lshl2_add_u32 s54, s44, s46
  s_lshl1_add_u32 s54, s54, s51
  s_mul_i32 s54, s54, 14336
  s_mul_i32 s55, s51, -28672
  s_add_u32 s55, s55, 12288
  v_mul_u32_u24 v200, 896, v192
  v_xor_b32 v201, v193, v194
  v_add_u32 v200, s54, v200
  v_lshl_add_u32 v2, v201, 4, v200
  v_xor_b32 v201, 4, v201
  v_lshl_add_u32 v201, v201, 4, v200
  v_add_u32 v3, 6144, v201
  v_add_u32 v4, s55, v2
  v_add_u32 v5, s55, v3
  s_lshr_b32 s55, s65, 1
  s_add_u32 m0, s55, 147456
  s_mov_b32 s78, 41984
  s_waitcnt lgkmcnt(0)
  s_mov_b64 s[12:13], s[86:87]
  s_mov_b64 s[8:9], s[84:85]
  buffer_load_dwordx4 v16, s[12:15], 0 offen lds
  s_mov_b64 s[16:17], s[92:93]
  s_mov_b64 s[36:37], s[94:95]
  s_lshr_b32 s47, s45, 2
  s_and_b32 s48, s45, 3
  s_lshl_b32 s54, s48, 2
  s_lshr_b32 s49, 0x5420, s54
  s_and_b32 s49, s49, 15
  s_lshr_b32 s50, 0x6331, s54
  s_and_b32 s50, s50, 15
  buffer_load_dwordx4 v16, s[12:15], s78 offen offset:1024 lds
  s_mov_b32 s18, 1605632
  s_mov_b32 s19, 0x20000
  s_mov_b32 s38, 3584
  s_mov_b32 s39, 0x20000
  v_and_b32 v200, 3, v192
  v_lshl_add_u32 v200, v195, 3, v200
  v_mul_u32_u24 v200, 3584, v200
  v_lshlrev_b32 v201, 1, v194
  v_xor_b32 v202, v201, v193
  s_mul_i32 s55, s47, 896
  s_add_u32 m0, s65, 0
  s_nop 0
  buffer_load_dwordx4 v2, s[8:11], 0 offen offset:0 lds
  s_lshl_b32 s56, s49, 7
  s_add_u32 s56, s56, s55
  s_lshl_b32 s57, s50, 7
  s_add_u32 s57, s57, s55
  s_mul_i32 s54, s46, 57344
  v_add_u32 v200, s54, v200
  s_cmp_eq_u32 s48, 2
  s_cselect_b32 s58, 4, 0
  v_lshl_add_u32 v201, v202, 4, v200
  buffer_load_dwordx4 v3, s[8:11], 0 offen offset:1024 lds
  v_add_u32 v6, s56, v201
  v_xor_b32 v201, s58, v202
  v_lshl_add_u32 v201, v201, 4, v200
  v_add_u32 v8, s57, v201
  v_add_u32 v7, 13312, v6
  v_add_u32 v9, 13312, v8
  s_sub_u32 s57, s57, 128
  v_xor_b32 v200, s58, v199
  v_lshl_add_u32 v200, v200, 4, s57
  v_lshl_add_u32 v201, v199, 4, s56
  buffer_load_dwordx4 v4, s[8:11], 0 offen offset:2048 lds
  v_cmp_gt_u32 vcc, 8, v199
  s_mov_b32 s30, 0x10000000
  s_mov_b32 s31, 0x20000
  v_cndmask_b32 v20, v200, v201, vcc
  s_lshl_b32 s54, s44, 6
  s_min_u32 s54, s54, 832
  s_add_u32 s98, s98, s54
  s_addc_u32 s99, s99, 0
  s_mov_b64 s[20:21], s[96:97]
  s_mov_b64 s[24:25], s[88:89]
  buffer_load_dwordx4 v5, s[8:11], 0 offen offset:3072 lds
  s_load_dwordx2 s[40:41], s[28:29], 0
  s_load_dwordx16 s[84:99], s[98:99], 0
  s_mov_b32 s66, 0x88888888
  s_mov_b32 s67, 0x88888888
  v_lshlrev_b32 v23, 4, v1
  s_lshr_b32 s54, s65, 1
  s_add_u32 s54, s54, 147456
  v_lshl_add_u32 v200, v195, 10, s54
  v_lshl_add_u32 v200, v198, 8, v200
  v_lshl_add_u32 v200, v196, 6, v200
  s_add_u32 m0, s65, 49152
  s_nop 0
  buffer_load_dwordx4 v6, s[16:19], 0 offen offset:0 lds
  v_lshl_add_u32 v200, v197, 3, v200
  v_lshl_add_u32 v17, v198, 5, v200
  v_xor_b32 v18, 32, v17
  s_mul_i32 s54, s45, 86016
  s_add_u32 s54, s54, 0x140000
  v_add_u32 v26, s54, v23
  s_lshl_b32 s55, s44, 12
  s_lshr_b32 s56, s65, 1
  s_add_u32 s55, s55, s56
  buffer_load_dwordx4 v7, s[16:19], 0 offen offset:1024 lds
  s_lshl_b32 s56, s44, 11
  s_add_u32 s56, s56, 57344
  s_cmp_eq_u32 s46, 2
  s_cselect_b32 s55, s56, s55
  s_cmp_eq_u32 s46, 3
  s_cselect_b32 s55, 0x40000000, s55
  s_cmp_ge_u32 s44, 14
  s_cselect_b32 s55, 0x40000000, s55
  v_add_u32 v19, s55, v26
  v_lshrrev_b32 v200, 1, v199
  s_add_u32 m0, s65, 51200
  s_nop 0
  buffer_load_dwordx4 v8, s[16:19], 0 offen offset:0 lds
  v_xor_b32 v200, v200, v194
  v_lshl_add_u32 v201, v199, 7, s65
  v_lshl_add_u32 v10, v200, 4, v201
  v_xor_b32 v11, 64, v10
  v_bfe_u32 v200, v1, 2, 3
  v_lshlrev_b32 v203, 7, v200
  v_lshl_add_u32 v203, v197, 3, v203
  v_and_b32 v200, 3, v192
  v_lshl_add_u32 v203, v200, 5, v203
  buffer_load_dwordx4 v9, s[16:19], 0 offen offset:1024 lds
  v_lshl_add_u32 v200, v195, 12, v203
  v_add_u32 v12, 49152, v200
  v_xor_b32 v13, 32, v12
  v_xor_b32 v14, 64, v12
  v_xor_b32 v15, 96, v12
  s_lshr_b32 s54, s65, 2
  s_add_u32 s54, s54, 155648
  v_lshl_add_u32 v21, v194, 3, s54
  v_mov_b32 v80, 0
  v_mov_b32 v81, 0
  s_lshr_b32 s78, s65, 2
  s_add_u32 m0, s78, 155648
  s_nop 0
  buffer_load_dwordx4 v20, s[36:39], 0 offen lds
  v_mov_b32 v82, 0
  v_mov_b32 v83, 0
  s_waitcnt lgkmcnt(0)
  s_cmp_lg_u32 s46, 2
  s_cbranch_scc1 L_nog
  v_writelane_b32 v80, s84, 3
  v_writelane_b32 v81, s85, 3
  v_writelane_b32 v82, s86, 3
  v_writelane_b32 v83, s87, 3
  v_writelane_b32 v80, s88, 19
  v_writelane_b32 v81, s89, 19
  v_writelane_b32 v82, s90, 19
  v_writelane_b32 v83, s91, 19
  v_writelane_b32 v80, s92, 35
  v_writelane_b32 v81, s93, 35
  v_writelane_b32 v82, s94, 35
  v_writelane_b32 v83, s95, 35
  v_writelane_b32 v80, s96, 51
  v_writelane_b32 v81, s97, 51
  v_writelane_b32 v82, s98, 51
  v_writelane_b32 v83, s99, 51
  v_mov_b32_dpp v80, v80 row_newbcast:3 row_mask:0xf bank_mask:0xf
  v_mov_b32_dpp v81, v81 row_newbcast:3 row_mask:0xf bank_mask:0xf
  v_mov_b32_dpp v82, v82 row_newbcast:3 row_mask:0xf bank_mask:0xf
  v_mov_b32_dpp v83, v83 row_newbcast:3 row_mask:0xf bank_mask:0xf
L_nog:
  s_add_u32 m0, s65, 16384
  s_movk_i32 s78, 128
  buffer_load_dwordx4 v2, s[8:11], s78 offen offset:0 lds
  buffer_load_dwordx4 v3, s[8:11], s78 offen offset:1024 lds
  buffer_load_dwordx4 v4, s[8:11], s78 offen offset:2048 lds
  buffer_load_dwordx4 v5, s[8:11], s78 offen offset:3072 lds
  s_add_u32 m0, s65, 65536
  s_mov_b32 s78, 229376
  buffer_load_dwordx4 v6, s[16:19], s78 offen offset:0 lds
  buffer_load_dwordx4 v7, s[16:19], s78 offen offset:1024 lds
  s_waitcnt vmcnt(15)
  s_add_u32 m0, s65, 67584
  s_nop 0
  buffer_load_dwordx4 v8, s[16:19], s78 offen offset:0 lds
  ds_read_b64_tr_b16 v[88:89], v18 offset:0
  ds_read_b64_tr_b16 v[90:91], v18 offset:512
  ds_read_b64_tr_b16 v[84:85], v17 offset:0
  ds_read_b64_tr_b16 v[86:87], v17 offset:512
  s_waitcnt lgkmcnt(3)
  v_mov_b32_dpp v88, v88 row_shr:3 row_mask:0xf bank_mask:0x8
  v_mov_b32_dpp v89, v89 row_shr:3 row_mask:0xf bank_mask:0x8
  s_waitcnt lgkmcnt(2)
  v_mov_b32_dpp v90, v90 row_shr:3 row_mask:0xf bank_mask:0x8
  v_mov_b32_dpp v91, v91 row_shr:3 row_mask:0xf bank_mask:0x8
  v_mov_b32_dpp v88, v88 row_shr:2 row_mask:0xf bank_mask:0x4
  v_mov_b32_dpp v89, v89 row_shr:2 row_mask:0xf bank_mask:0x4
  buffer_load_dwordx4 v9, s[16:19], s78 offen offset:1024 lds
  v_mov_b32_dpp v90, v90 row_shr:2 row_mask:0xf bank_mask:0x4
  v_mov_b32_dpp v91, v91 row_shr:2 row_mask:0xf bank_mask:0x4
  v_mov_b32_dpp v88, v88 row_shr:1 row_mask:0xf bank_mask:0x2
  v_mov_b32_dpp v89, v89 row_shr:1 row_mask:0xf bank_mask:0x2
  v_mov_b32_dpp v90, v90 row_shr:1 row_mask:0xf bank_mask:0x2
  v_mov_b32_dpp v91, v91 row_shr:1 row_mask:0xf bank_mask:0x2
  v_cndmask_b32_e64 v88, v88, v80, s[66:67]
  v_cndmask_b32_e64 v89, v89, v81, s[66:67]
  v_cndmask_b32_e64 v90, v90, v82, s[66:67]
  v_cndmask_b32_e64 v91, v91, v83, s[66:67]
  s_add_u32 s40, s40, 0x7f4a7c15
  s_addc_u32 s41, s41, 0x9e3779b9
  s_waitcnt lgkmcnt(0)
  buffer_store_dwordx4 v[84:87], v19, s[28:31], 0 offen offset:0 sc1
  v_mov_b32 v52, s40
  v_mov_b32 v53, s41
  s_lshl4_add_u32 s54, s44, s45
  s_lshl4_add_u32 s55, s54, s46
  s_lshl_b32 s55, s55, 3
  s_add_u32 s55, s55, 4096
  v_min_u32 v200, 1, v1
  v_lshl_add_u32 v29, v200, 30, s55
  s_lshl_b32 s54, s45, 7
  s_add_u32 s54, s54, 4096
  buffer_store_dwordx4 v[88:91], v19, s[28:31], 0 offen offset:1024 sc1
  v_lshrrev_b32 v200, 2, v1
  v_lshl_add_u32 v200, v200, 11, s54
  v_lshl_add_u32 v30, v197, 3, v200
  s_mov_b32 s53, 200000
  s_mov_b32 s60, 0x3fb8aa3b
  s_mov_b32 s61, 0x3f3504f3
  s_mov_b32 s62, 0x3fb8aa3b
  s_mov_b32 s63, 0xb5c1a2a0
  s_mov_b32 s64, 0x358637bd
  s_mov_b32 s68, 0xffff
  s_lshl_b32 s69, s40, 16
  v_mov_b32 v213, s69
  s_and_b32 s42, s40, 0xff
  s_bfe_u32 s43, s40, 0x80008
  s_mov_b32 s3, 0x03020106
  s_mov_b32 s4, 0x03020107
  s_add_u32 m0, s65, 32768
  s_movk_i32 s78, 256
  buffer_load_dwordx4 v2, s[8:11], s78 offen offset:0 lds
  s_cmp_eq_u32 s52, 7
  s_cselect_b32 s22, 0, 1605632
  s_cselect_b32 s26, 0, 401408
  s_mov_b32 s23, 0x20000
  s_mov_b32 s27, 0x20000
  s_mov_b32 s34, 1835008
  s_mov_b32 s35, 0x20000
  v_add_u32 v24, 65536, v23
  v_add_u32 v25, 65536, v24
  s_mul_i32 s54, s44, 589824
  s_add_u32 s54, s54, 0x300000
  s_lshl1_add_u32 s55, s46, s51
  s_lshl_b32 s55, s55, 10
  s_add_u32 s55, s55, s54
  v_add_u32 v27, s55, v23
  buffer_load_dwordx4 v3, s[8:11], s78 offen offset:1024 lds
  v_xor_b32 v28, 1024, v27
  s_mul_i32 s54, s47, 14
  s_lshl1_add_u32 s70, s49, s54
  s_add_u32 s71, s70, 1
  s_lshl1_add_u32 s72, s50, s54
  s_add_u32 s73, s72, 1
  s_cmp_eq_u32 s48, 2
  s_cselect_b32 s72, s73, s72
  s_cselect_b32 s73, 0x20000, s73
  s_cmp_eq_u32 s48, 1
  s_cselect_b32 s73, 0x20000, s73
  s_min_u32 s54, s70, s72
  s_mul_i32 s55, s51, 28
  s_sub_u32 s54, s54, s55
  s_add_u32 s54, s54, 3
  s_and_b32 s56, s44, 3
  buffer_load_dwordx4 v4, s[8:11], s78 offen offset:2048 lds
  s_mul_i32 s56, s56, 6
  s_add_u32 s56, s56, 22
  v_add_u32 v200, s56, v1
  v_subrev_u32 v201, 25, v200
  v_min_u32 v200, v200, v201
  v_subrev_u32 v201, 25, v200
  v_min_u32 v200, v200, v201
  v_add_u32 v200, s54, v200
  v_subrev_u32 v201, 28, v200
  v_min_u32 v200, v200, v201
  v_add_u32 v200, s55, v200
  v_writelane_b32 v200, s70, 0
  v_writelane_b32 v200, s71, 1
  v_writelane_b32 v200, s72, 2
  v_lshlrev_b32 v212, 13, v200
  v_mul_u32_u24 v22, 28672, v200
  s_lshl_b32 s70, s70, 13
  buffer_load_dwordx4 v5, s[8:11], s78 offen offset:3072 lds
  s_lshl_b32 s71, s71, 13
  s_lshl_b32 s72, s72, 13
  s_lshl_b32 s73, s73, 13
  v_readlane_b32 s77, v212, 3
  v_readlane_b32 s76, v212, 4
  s_lshl_b32 s74, s45, 13
  s_add_u32 s74, s74, 458752
  s_mul_i32 s81, s46, 25088
  s_lshl1_add_u32 s54, s44, s51
  s_lshl_b32 s54, s54, 10
  s_lshl3_add_u32 s54, s46, s54
  s_add_u32 s54, s54, 36864
  v_lshl_add_u32 v31, v193, 7, s54
  s_lshl_b32 s54, s52, 7
  v_mul_u32_u24 v200, 896, v192
  v_lshl_add_u32 v200, v202, 4, v200
  s_add_u32 m0, s65, 81920
  s_mov_b32 s78, 458752
  buffer_load_dwordx4 v6, s[16:19], s78 offen offset:0 lds
  v_add_u32 v32, s54, v200
  v_add_u32 v33, 13312, v32
  v_add_u32 v34, 5120, v32
  v_add_u32 v35, 18432, v32
  v_mul_u32_u24 v200, 896, v195
  v_sub_u32 v36, v33, v200
  v_add_u32 v37, 3328, v36
  v_lshl_add_u32 v40, v195, 11, v203
  v_xor_b32 v41, 32, v40
  v_xor_b32 v42, 64, v40
  v_xor_b32 v43, 96, v40
  v_add_u32 v44, 65536, v40
  v_add_u32 v45, 65536, v41
  v_add_u32 v46, 65536, v42
  v_add_u32 v47, 65536, v43
  s_waitcnt vmcnt(15)
  buffer_load_dwordx4 v7, s[16:19], s78 offen offset:1024 lds
  ds_read_b64 v[130:131], v21 offset:0
  ds_read_b64 v[134:135], v21 offset:32
  ds_read_b64 v[138:139], v21 offset:64
  ds_read_b64 v[142:143], v21 offset:96
  ds_read_b64 v[146:147], v21 offset:128
  ds_read_b64 v[150:151], v21 offset:160
  ds_read_b64 v[154:155], v21 offset:192
  ds_read_b64 v[158:159], v21 offset:224
  s_waitcnt lgkmcnt(7)
  v_lshlrev_b32 v128, 16, v130
  v_and_b32 v129, 0xffff0000, v130
  v_lshlrev_b32 v130, 16, v131
  v_and_b32 v131, 0xffff0000, v131
  s_waitcnt lgkmcnt(6)
  v_lshlrev_b32 v132, 16, v134
  v_and_b32 v133, 0xffff0000, v134
  v_lshlrev_b32 v134, 16, v135
  v_and_b32 v135, 0xffff0000, v135
  s_waitcnt lgkmcnt(5)
  v_lshlrev_b32 v136, 16, v138
  v_and_b32 v137, 0xffff0000, v138
  v_lshlrev_b32 v138, 16, v139
  v_and_b32 v139, 0xffff0000, v139
  s_waitcnt lgkmcnt(4)
  v_lshlrev_b32 v140, 16, v142
  v_and_b32 v141, 0xffff0000, v142
  v_lshlrev_b32 v142, 16, v143
  v_and_b32 v143, 0xffff0000, v143
  s_waitcnt lgkmcnt(3)
  v_lshlrev_b32 v144, 16, v146
  v_and_b32 v145, 0xffff0000, v146
  v_lshlrev_b32 v146, 16, v147
  v_and_b32 v147, 0xffff0000, v147
  s_waitcnt lgkmcnt(2)
  v_lshlrev_b32 v148, 16, v150
  s_add_u32 m0, s65, 83968
  s_nop 0
  buffer_load_dwordx4 v8, s[16:19], s78 offen offset:0 lds
  v_and_b32 v149, 0xffff0000, v150
  v_lshlrev_b32 v150, 16, v151
  v_and_b32 v151, 0xffff0000, v151
  s_waitcnt lgkmcnt(1)
  v_lshlrev_b32 v152, 16, v154
  v_and_b32 v153, 0xffff0000, v154
  v_lshlrev_b32 v154, 16, v155
  v_and_b32 v155, 0xffff0000, v155
  s_waitcnt lgkmcnt(0)
  v_lshlrev_b32 v156, 16, v158
  v_and_b32 v157, 0xffff0000, v158
  v_lshlrev_b32 v158, 16, v159
  v_and_b32 v159, 0xffff0000, v159
  ds_read_b128 a[0:3], v10 offset:0
  ds_read_b128 a[4:7], v10 offset:2048
  ds_read_b128 a[8:11], v11 offset:0
  ds_read_b128 a[12:15], v11 offset:2048
  buffer_load_dwordx4 v9, s[16:19], s78 offen offset:1024 lds
  s_barrier
  ds_read_b64_tr_b16 v[224:225], v12 offset:0
  ds_read_b64_tr_b16 v[226:227], v12 offset:1024
  ds_read_b64_tr_b16 v[228:229], v13 offset:0
  ds_read_b64_tr_b16 v[230:231], v13 offset:1024
  ds_read_b64_tr_b16 v[232:233], v14 offset:0
  ds_read_b64_tr_b16 v[234:235], v14 offset:1024
  s_waitcnt lgkmcnt(6)
  s_add_u32 m0, s65, 0
  s_movk_i32 s78, 384
  buffer_load_dwordx4 v2, s[8:11], s78 offen offset:0 lds
  ds_read_b64_tr_b16 v[236:237], v15 offset:0
  ds_read_b64_tr_b16 v[238:239], v15 offset:1024
  s_waitcnt lgkmcnt(6)
  v_mfma_f32_16x16x32_bf16 v[64:67], v[224:227], a[0:3], v[128:131]
  ds_read_b64_tr_b16 v[240:241], v12 offset:2048
  v_add_u32 v48, 65536, v44
  v_mfma_f32_16x16x32_bf16 v[68:71], v[224:227], a[4:7], v[128:131]
  ds_read_b64_tr_b16 v[242:243], v12 offset:3072
  v_add_u32 v49, 65536, v45
  s_waitcnt lgkmcnt(6)
  v_mfma_f32_16x16x32_bf16 v[72:75], v[228:231], a[0:3], v[132:135]
  ds_read_b64_tr_b16 v[244:245], v13 offset:2048
  v_add_u32 v50, 65536, v46
  buffer_load_dwordx4 v3, s[8:11], s78 offen offset:1024 lds
  v_mfma_f32_16x16x32_bf16 v[76:79], v[228:231], a[4:7], v[132:135]
  ds_read_b64_tr_b16 v[246:247], v13 offset:3072
  v_add_u32 v51, 65536, v47
  s_waitcnt lgkmcnt(6)
  v_mfma_f32_16x16x32_bf16 v[80:83], v[232:235], a[0:3], v[136:139]
  ds_read_b64_tr_b16 v[248:249], v14 offset:2048
  s_and_b32 s55, s46, 1
  v_mfma_f32_16x16x32_bf16 v[84:87], v[232:235], a[4:7], v[136:139]
  ds_read_b64_tr_b16 v[250:251], v14 offset:3072
  s_lshl1_add_u32 s54, s45, s55
  s_waitcnt lgkmcnt(6)
  v_mfma_f32_16x16x32_bf16 v[88:91], v[236:239], a[0:3], v[140:143]
  ds_read_b64_tr_b16 v[252:253], v15 offset:2048
  s_lshl_b32 s54, s54, 14
  buffer_load_dwordx4 v4, s[8:11], s78 offen offset:2048 lds
  v_mfma_f32_16x16x32_bf16 v[92:95], v[236:239], a[4:7], v[140:143]
  ds_read_b64_tr_b16 v[254:255], v15 offset:3072
  s_add_u32 s54, s54, 0x40000
  s_waitcnt lgkmcnt(6)
  v_mfma_f32_16x16x32_bf16 v[96:99], v[240:243], a[0:3], v[144:147]
  ds_read_b64_tr_b16 v[224:225], v12 offset:8192
  s_lshr_b32 s56, s46, 1
  v_mfma_f32_16x16x32_bf16 v[100:103], v[240:243], a[4:7], v[144:147]
  ds_read_b64_tr_b16 v[226:227], v12 offset:9216
  s_lshl_b32 s57, s56, 13
  s_waitcnt lgkmcnt(6)
  v_mfma_f32_16x16x32_bf16 v[104:107], v[244:247], a[0:3], v[148:151]
  ds_read_b64_tr_b16 v[228:229], v13 offset:8192
  s_add_u32 s57, s57, s54
  v_mfma_f32_16x16x32_bf16 v[108:111], v[244:247], a[4:7], v[148:151]
  ds_read_b64_tr_b16 v[230:231], v13 offset:9216
  v_add_u32 v56, s57, v23
  s_waitcnt lgkmcnt(6)
  v_mfma_f32_16x16x32_bf16 v[112:115], v[248:251], a[0:3], v[152:155]
  ds_read_b64_tr_b16 v[232:233], v14 offset:8192
  s_lshl_b32 s57, s44, 10
  v_mfma_f32_16x16x32_bf16 v[116:119], v[248:251], a[4:7], v[152:155]
  ds_read_b64_tr_b16 v[234:235], v14 offset:9216
  s_add_u32 s57, s57, s54
  s_waitcnt lgkmcnt(6)
  v_mfma_f32_16x16x32_bf16 v[120:123], v[252:255], a[0:3], v[156:159]
  ds_read_b64_tr_b16 v[236:237], v15 offset:8192
  s_lshl_b32 s56, s56, 30
  v_mfma_f32_16x16x32_bf16 v[124:127], v[252:255], a[4:7], v[156:159]
  ds_read_b64_tr_b16 v[238:239], v15 offset:9216
  s_add_u32 s57, s57, s56
  s_waitcnt lgkmcnt(6)
  v_mfma_f32_16x16x32_bf16 v[64:67], v[224:227], a[8:11], v[64:67]
  ds_read_b64_tr_b16 v[240:241], v12 offset:10240
  v_add_u32 v55, s57, v23
  v_mfma_f32_16x16x32_bf16 v[68:71], v[224:227], a[12:15], v[68:71]
  ds_read_b64_tr_b16 v[242:243], v12 offset:11264
  s_lshr_b32 s54, s65, 2
  s_waitcnt lgkmcnt(6)
  v_mfma_f32_16x16x32_bf16 v[72:75], v[228:231], a[8:11], v[72:75]
  ds_read_b64_tr_b16 v[244:245], v13 offset:10240
  v_add_u32 v57, s54, v23
  v_mfma_f32_16x16x32_bf16 v[76:79], v[228:231], a[12:15], v[76:79]
  ds_read_b64_tr_b16 v[246:247], v13 offset:11264
  s_add_u32 s54, s54, 159744
  s_waitcnt lgkmcnt(6)
  v_mfma_f32_16x16x32_bf16 v[80:83], v[232:235], a[8:11], v[80:83]
  ds_read_b64_tr_b16 v[248:249], v14 offset:10240
  v_add_u32 v59, s54, v23
  v_mfma_f32_16x16x32_bf16 v[84:87], v[232:235], a[12:15], v[84:87]
  ds_read_b64_tr_b16 v[250:251], v14 offset:11264
  s_lshl_b32 s55, s55, 12
  s_waitcnt lgkmcnt(6)
  v_mfma_f32_16x16x32_bf16 v[88:91], v[236:239], a[8:11], v[88:91]
  ds_read_b64_tr_b16 v[252:253], v15 offset:10240
  v_add_u32 v58, s55, v23
  v_mfma_f32_16x16x32_bf16 v[92:95], v[236:239], a[12:15], v[92:95]
  buffer_load_dwordx4 v5, s[8:11], s78 offen offset:3072 lds
  ds_read_b64_tr_b16 v[254:255], v15 offset:11264
  s_waitcnt vmcnt(18)
  ds_read_b128 a[16:19], v10 offset:16384
  ds_read_b128 a[20:23], v10 offset:18432
  ds_read_b128 a[24:27], v11 offset:16384
  ds_read_b128 a[28:31], v11 offset:18432
  s_lshl4_add_u32 s54, s44, s45
  s_lshl_b32 s54, s54, 14
  s_add_u32 s54, s54, s65
  s_add_u32 s54, s54, 0xe00000
  v_add_u32 v39, s54, v23
  v_xor_b32 v60, 0x20000, v39
  s_lshl2_add_u32 s54, s44, s46
  s_lshl1_add_u32 s54, s54, s51
  s_mul_i32 s54, s54, 14336
  s_lshl_b32 s55, s52, 7
  s_add_u32 s54, s54, s55
  v_mul_u32_u24 v200, 896, v199
  s_waitcnt lgkmcnt(0)
  s_add_u32 m0, s65, 16384
  s_movk_i32 s78, 512
  buffer_load_dwordx4 v2, s[8:11], s78 offen offset:0 lds
  v_lshl_add_u32 v200, v194, 3, v200
  v_add_u32 v38, s54, v200
  v_mov_b32 v208, s64
  v_mov_b32 v209, s64
  v_mov_b32 v210, s64
  v_mov_b32 v211, s64
  v_and_b32 v200, 1, v1
  v_lshlrev_b32 v200, 4, v200
  v_mov_b32 v201, 0x3f80
  v_lshlrev_b32 v200, v200, v201
  v_lshrrev_b32 v201, 1, v199
  v_lshlrev_b32 v204, 1, v194
  v_sub_u32 v201, v201, v204
  s_waitcnt vmcnt(15)
  buffer_load_dwordx4 v3, s[8:11], s78 offen offset:1024 lds
  s_barrier
  v_mfma_f32_16x16x32_bf16 v[96:99], v[240:243], a[8:11], v[96:99]
  ds_read_b64_tr_b16 v[224:225], v12 offset:16384
  v_mov_b32 v216, 0
  v_mfma_f32_16x16x32_bf16 v[100:103], v[240:243], a[12:15], v[100:103]
  buffer_load_dwordx4 v4, s[8:11], s78 offen offset:2048 lds
  ds_read_b64_tr_b16 v[226:227], v12 offset:17408
  v_mfma_f32_16x16x32_bf16 v[104:107], v[244:247], a[8:11], v[104:107]
  ds_read_b64_tr_b16 v[228:229], v13 offset:16384
  v_mov_b32 v217, 0
  v_mfma_f32_16x16x32_bf16 v[108:111], v[244:247], a[12:15], v[108:111]
  ds_read_b64_tr_b16 v[230:231], v13 offset:17408
  v_mov_b32 v220, 0
  v_mfma_f32_16x16x32_bf16 v[112:115], v[248:251], a[8:11], v[112:115]
  ds_read_b64_tr_b16 v[232:233], v14 offset:16384
  v_mov_b32 v221, 0
  v_mfma_f32_16x16x32_bf16 v[116:119], v[248:251], a[12:15], v[116:119]
  s_waitcnt vmcnt(15)
  buffer_store_dwordx2 v[52:53], v29, s[28:31], 0 offen sc1
  ds_read_b64_tr_b16 v[234:235], v14 offset:17408
  v_mfma_f32_16x16x32_bf16 v[120:123], v[252:255], a[8:11], v[120:123]
  ds_read_b64_tr_b16 v[236:237], v15 offset:16384
  v_cmp_eq_u32 vcc, 0, v201
  s_nop 1
  s_nop 0
  v_cndmask_b32 v218, v216, v200, vcc
  v_mfma_f32_16x16x32_bf16 v[124:127], v[252:255], a[12:15], v[124:127]
  ds_read_b64_tr_b16 v[238:239], v15 offset:17408
  v_cmp_eq_u32 vcc, 1, v201
  s_nop 1
  s_nop 0
  v_cndmask_b32 v219, v216, v200, vcc
  s_waitcnt lgkmcnt(6)
  v_mfma_f32_16x16x32_bf16 v[64:67], v[224:227], a[16:19], v[64:67]
  ds_read_b64_tr_b16 v[240:241], v12 offset:18432
  v_mfma_f32_16x16x32_bf16 v[68:71], v[224:227], a[20:23], v[68:71]
  buffer_load_dwordx4 v5, s[8:11], s78 offen offset:3072 lds
  ds_read_b64_tr_b16 v[242:243], v12 offset:19456
  s_waitcnt lgkmcnt(6)
  v_mfma_f32_16x16x32_bf16 v[72:75], v[228:231], a[16:19], v[72:75]
  ds_read_b64_tr_b16 v[244:245], v13 offset:18432
  v_mfma_f32_16x16x32_bf16 v[76:79], v[228:231], a[20:23], v[76:79]
  ds_read_b64_tr_b16 v[246:247], v13 offset:19456
  s_waitcnt lgkmcnt(6)
  v_mfma_f32_16x16x32_bf16 v[80:83], v[232:235], a[16:19], v[80:83]
  ds_read_b64_tr_b16 v[248:249], v14 offset:18432
  v_mfma_f32_16x16x32_bf16 v[84:87], v[232:235], a[20:23], v[84:87]
  s_add_u32 m0, s65, 49152
  s_mov_b32 s78, 688128
  buffer_load_dwordx4 v6, s[16:19], s78 offen offset:0 lds
  ds_read_b64_tr_b16 v[250:251], v14 offset:19456
  s_waitcnt lgkmcnt(6)
  v_mfma_f32_16x16x32_bf16 v[88:91], v[236:239], a[16:19], v[88:91]
  ds_read_b64_tr_b16 v[252:253], v15 offset:18432
  v_mfma_f32_16x16x32_bf16 v[92:95], v[236:239], a[20:23], v[92:95]
  ds_read_b64_tr_b16 v[254:255], v15 offset:19456
  s_waitcnt lgkmcnt(6)
  v_mfma_f32_16x16x32_bf16 v[96:99], v[240:243], a[16:19], v[96:99]
  ds_read_b64_tr_b16 v[224:225], v12 offset:24576
  v_mfma_f32_16x16x32_bf16 v[100:103], v[240:243], a[20:23], v[100:103]
  buffer_load_dwordx4 v7, s[16:19], s78 offen offset:1024 lds
  ds_read_b64_tr_b16 v[226:227], v12 offset:25600
  s_waitcnt lgkmcnt(6)
  v_mfma_f32_16x16x32_bf16 v[104:107], v[244:247], a[16:19], v[104:107]
  ds_read_b64_tr_b16 v[228:229], v13 offset:24576
  v_mfma_f32_16x16x32_bf16 v[108:111], v[244:247], a[20:23], v[108:111]
  ds_read_b64_tr_b16 v[230:231], v13 offset:25600
  s_waitcnt lgkmcnt(6)
  v_mfma_f32_16x16x32_bf16 v[112:115], v[248:251], a[16:19], v[112:115]
  ds_read_b64_tr_b16 v[232:233], v14 offset:24576
  v_mfma_f32_16x16x32_bf16 v[116:119], v[248:251], a[20:23], v[116:119]
  ds_read_b64_tr_b16 v[234:235], v14 offset:25600
  s_add_u32 m0, s65, 51200
  s_nop 0
  buffer_load_dwordx4 v8, s[16:19], s78 offen offset:0 lds
  s_waitcnt lgkmcnt(6)
  v_mfma_f32_16x16x32_bf16 v[120:123], v[252:255], a[16:19], v[120:123]
  ds_read_b64_tr_b16 v[236:237], v15 offset:24576
  v_mfma_f32_16x16x32_bf16 v[124:127], v[252:255], a[20:23], v[124:127]
  ds_read_b64_tr_b16 v[238:239], v15 offset:25600
  s_waitcnt lgkmcnt(6)
  v_mfma_f32_16x16x32_bf16 v[64:67], v[224:227], a[24:27], v[64:67]
  ds_read_b64_tr_b16 v[240:241], v12 offset:26624
  v_mfma_f32_16x16x32_bf16 v[68:71], v[224:227], a[28:31], v[68:71]
  ds_read_b64_tr_b16 v[242:243], v12 offset:27648
  buffer_load_dwordx4 v9, s[16:19], s78 offen offset:1024 lds
  s_waitcnt lgkmcnt(6)
  v_mfma_f32_16x16x32_bf16 v[72:75], v[228:231], a[24:27], v[72:75]
  ds_read_b64_tr_b16 v[244:245], v13 offset:26624
  v_mfma_f32_16x16x32_bf16 v[76:79], v[228:231], a[28:31], v[76:79]
  ds_read_b64_tr_b16 v[246:247], v13 offset:27648
  s_waitcnt lgkmcnt(6)
  v_mfma_f32_16x16x32_bf16 v[80:83], v[232:235], a[24:27], v[80:83]
  ds_read_b64_tr_b16 v[248:249], v14 offset:26624
  v_mfma_f32_16x16x32_bf16 v[84:87], v[232:235], a[28:31], v[84:87]
  ds_read_b64_tr_b16 v[250:251], v14 offset:27648
  s_waitcnt lgkmcnt(6)
  v_mfma_f32_16x16x32_bf16 v[88:91], v[236:239], a[24:27], v[88:91]
  ds_read_b64_tr_b16 v[252:253], v15 offset:26624
  v_mfma_f32_16x16x32_bf16 v[92:95], v[236:239], a[28:31], v[92:95]
  ds_read_b64_tr_b16 v[254:255], v15 offset:27648
  s_waitcnt vmcnt(17)
  ds_read_b128 a[32:35], v10 offset:32768
  ds_read_b128 a[36:39], v10 offset:34816
  ds_read_b128 a[40:43], v11 offset:32768
  ds_read_b128 a[44:47], v11 offset:34816
  s_waitcnt lgkmcnt(0)
  s_add_u32 m0, s65, 32768
  s_movk_i32 s78, 640
  buffer_load_dwordx4 v2, s[8:11], s78 offen offset:0 lds
  buffer_load_dwordx4 v3, s[8:11], s78 offen offset:1024 lds
  s_waitcnt vmcnt(15)
  buffer_load_dwordx4 v4, s[8:11], s78 offen offset:2048 lds
  s_barrier
  v_mfma_f32_16x16x32_bf16 v[96:99], v[240:243], a[24:27], v[96:99]
  ds_read_b64_tr_b16 v[224:225], v12 offset:32768
  v_mfma_f32_16x16x32_bf16 v[100:103], v[240:243], a[28:31], v[100:103]
  ds_read_b64_tr_b16 v[226:227], v12 offset:33792
  v_mfma_f32_16x16x32_bf16 v[104:107], v[244:247], a[24:27], v[104:107]
  buffer_load_dwordx4 v5, s[8:11], s78 offen offset:3072 lds
  ds_read_b64_tr_b16 v[228:229], v13 offset:32768
  v_mfma_f32_16x16x32_bf16 v[108:111], v[244:247], a[28:31], v[108:111]
  ds_read_b64_tr_b16 v[230:231], v13 offset:33792
  v_mfma_f32_16x16x32_bf16 v[112:115], v[248:251], a[24:27], v[112:115]
  ds_read_b64_tr_b16 v[232:233], v14 offset:32768
  v_mfma_f32_16x16x32_bf16 v[116:119], v[248:251], a[28:31], v[116:119]
  ds_read_b64_tr_b16 v[234:235], v14 offset:33792
  v_mfma_f32_16x16x32_bf16 v[120:123], v[252:255], a[24:27], v[120:123]
  s_add_u32 m0, s65, 65536
  s_mov_b32 s78, 917504
  buffer_load_dwordx4 v6, s[16:19], s78 offen offset:0 lds
  ds_read_b64_tr_b16 v[236:237], v15 offset:32768
  v_mfma_f32_16x16x32_bf16 v[124:127], v[252:255], a[28:31], v[124:127]
  ds_read_b64_tr_b16 v[238:239], v15 offset:33792
  s_waitcnt lgkmcnt(6)
  v_mfma_f32_16x16x32_bf16 v[64:67], v[224:227], a[32:35], v[64:67]
  ds_read_b64_tr_b16 v[240:241], v12 offset:34816
  v_mfma_f32_16x16x32_bf16 v[68:71], v[224:227], a[36:39], v[68:71]
  ds_read_b64_tr_b16 v[242:243], v12 offset:35840
  s_waitcnt lgkmcnt(6)
  v_mfma_f32_16x16x32_bf16 v[72:75], v[228:231], a[32:35], v[72:75]
  buffer_load_dwordx4 v7, s[16:19], s78 offen offset:1024 lds
  ds_read_b64_tr_b16 v[244:245], v13 offset:34816
  v_mfma_f32_16x16x32_bf16 v[76:79], v[228:231], a[36:39], v[76:79]
  ds_read_b64_tr_b16 v[246:247], v13 offset:35840
  s_waitcnt lgkmcnt(6)
  v_mfma_f32_16x16x32_bf16 v[80:83], v[232:235], a[32:35], v[80:83]
  ds_read_b64_tr_b16 v[248:249], v14 offset:34816
  v_mfma_f32_16x16x32_bf16 v[84:87], v[232:235], a[36:39], v[84:87]
  ds_read_b64_tr_b16 v[250:251], v14 offset:35840
  s_waitcnt lgkmcnt(6)
  v_mfma_f32_16x16x32_bf16 v[88:91], v[236:239], a[32:35], v[88:91]
  ds_read_b64_tr_b16 v[252:253], v15 offset:34816
  v_mfma_f32_16x16x32_bf16 v[92:95], v[236:239], a[36:39], v[92:95]
  ds_read_b64_tr_b16 v[254:255], v15 offset:35840
  s_waitcnt lgkmcnt(6)
  v_mfma_f32_16x16x32_bf16 v[96:99], v[240:243], a[32:35], v[96:99]
  ds_read_b64_tr_b16 v[224:225], v12 offset:40960
  v_mfma_f32_16x16x32_bf16 v[100:103], v[240:243], a[36:39], v[100:103]
  ds_read_b64_tr_b16 v[226:227], v12 offset:41984
  s_waitcnt lgkmcnt(6)
  v_mfma_f32_16x16x32_bf16 v[104:107], v[244:247], a[32:35], v[104:107]
  ds_read_b64_tr_b16 v[228:229], v13 offset:40960
  v_mfma_f32_16x16x32_bf16 v[108:111], v[244:247], a[36:39], v[108:111]
  ds_read_b64_tr_b16 v[230:231], v13 offset:41984
  s_waitcnt lgkmcnt(6)
  v_mfma_f32_16x16x32_bf16 v[112:115], v[248:251], a[32:35], v[112:115]
  ds_read_b64_tr_b16 v[232:233], v14 offset:40960
  v_mfma_f32_16x16x32_bf16 v[116:119], v[248:251], a[36:39], v[116:119]
  ds_read_b64_tr_b16 v[234:235], v14 offset:41984
  s_waitcnt lgkmcnt(6)
  v_mfma_f32_16x16x32_bf16 v[120:123], v[252:255], a[32:35], v[120:123]
  ds_read_b64_tr_b16 v[236:237], v15 offset:40960
  v_mfma_f32_16x16x32_bf16 v[124:127], v[252:255], a[36:39], v[124:127]
  ds_read_b64_tr_b16 v[238:239], v15 offset:41984
  s_waitcnt lgkmcnt(6)
  v_mfma_f32_16x16x32_bf16 v[64:67], v[224:227], a[40:43], v[64:67]
  ds_read_b64_tr_b16 v[240:241], v12 offset:43008
  v_mfma_f32_16x16x32_bf16 v[68:71], v[224:227], a[44:47], v[68:71]
  ds_read_b64_tr_b16 v[242:243], v12 offset:44032
  s_waitcnt lgkmcnt(6)
  v_mfma_f32_16x16x32_bf16 v[72:75], v[228:231], a[40:43], v[72:75]
  s_add_u32 m0, s65, 67584
  s_nop 0
  buffer_load_dwordx4 v8, s[16:19], s78 offen offset:0 lds
  ds_read_b64_tr_b16 v[244:245], v13 offset:43008
  v_mfma_f32_16x16x32_bf16 v[76:79], v[228:231], a[44:47], v[76:79]
  ds_read_b64_tr_b16 v[246:247], v13 offset:44032
  s_waitcnt lgkmcnt(6)
  v_mfma_f32_16x16x32_bf16 v[80:83], v[232:235], a[40:43], v[80:83]
  ds_read_b64_tr_b16 v[248:249], v14 offset:43008
  v_mfma_f32_16x16x32_bf16 v[84:87], v[232:235], a[44:47], v[84:87]
  ds_read_b64_tr_b16 v[250:251], v14 offset:44032
  s_waitcnt lgkmcnt(6)
  v_mfma_f32_16x16x32_bf16 v[88:91], v[236:239], a[40:43], v[88:91]
  ds_read_b64_tr_b16 v[252:253], v15 offset:43008
  v_mfma_f32_16x16x32_bf16 v[92:95], v[236:239], a[44:47], v[92:95]
  buffer_load_dwordx4 v9, s[16:19], s78 offen offset:1024 lds
  ds_read_b64_tr_b16 v[254:255], v15 offset:44032
  s_waitcnt vmcnt(17)
  ds_read_b128 a[48:51], v10 offset:0
  ds_read_b128 a[52:55], v10 offset:2048
  ds_read_b128 a[56:59], v11 offset:0
  ds_read_b128 a[60:63], v11 offset:2048
  buffer_load_dwordx2 v[222:223], v30, s[28:31], 0 offen sc1
  s_waitcnt lgkmcnt(0)
  s_add_u32 m0, s65, 0
  s_movk_i32 s78, 768
  buffer_load_dwordx4 v2, s[8:11], s78 offen offset:0 lds
  buffer_load_dwordx4 v3, s[8:11], s78 offen offset:1024 lds
  buffer_load_dwordx4 v4, s[8:11], s78 offen offset:2048 lds
  buffer_load_dwordx4 v5, s[8:11], s78 offen offset:3072 lds
  s_waitcnt vmcnt(13)
  s_barrier
  s_add_u32 m0, s65, 81920
  s_mov_b32 s78, 1146880
  buffer_load_dwordx4 v6, s[16:19], s78 offen offset:0 lds
  v_mfma_f32_16x16x32_bf16 v[96:99], v[240:243], a[40:43], v[96:99]
  ds_read_b64_tr_b16 v[224:225], v12 offset:0
  v_mfma_f32_16x16x32_bf16 v[100:103], v[240:243], a[44:47], v[100:103]
  ds_read_b64_tr_b16 v[226:227], v12 offset:1024
  v_mfma_f32_16x16x32_bf16 v[104:107], v[244:247], a[40:43], v[104:107]
  ds_read_b64_tr_b16 v[228:229], v13 offset:0
  v_mfma_f32_16x16x32_bf16 v[108:111], v[244:247], a[44:47], v[108:111]
  buffer_load_dwordx4 v7, s[16:19], s78 offen offset:1024 lds
  ds_read_b64_tr_b16 v[230:231], v13 offset:1024
  v_mfma_f32_16x16x32_bf16 v[112:115], v[248:251], a[40:43], v[112:115]
  ds_read_b64_tr_b16 v[232:233], v14 offset:0
  v_mfma_f32_16x16x32_bf16 v[116:119], v[248:251], a[44:47], v[116:119]
  ds_read_b64_tr_b16 v[234:235], v14 offset:1024
  v_mfma_f32_16x16x32_bf16 v[120:123], v[252:255], a[40:43], v[120:123]
  ds_read_b64_tr_b16 v[236:237], v15 offset:0
  v_mfma_f32_16x16x32_bf16 v[124:127], v[252:255], a[44:47], v[124:127]
  s_add_u32 m0, s65, 83968
  s_nop 0
  buffer_load_dwordx4 v8, s[16:19], s78 offen offset:0 lds
  ds_read_b64_tr_b16 v[238:239], v15 offset:1024
  s_waitcnt lgkmcnt(6)
  v_mfma_f32_16x16x32_bf16 v[64:67], v[224:227], a[48:51], v[64:67]
  ds_read_b64_tr_b16 v[240:241], v12 offset:2048
  v_mfma_f32_16x16x32_bf16 v[68:71], v[224:227], a[52:55], v[68:71]
  ds_read_b64_tr_b16 v[242:243], v12 offset:3072
  s_waitcnt lgkmcnt(6)
  v_mfma_f32_16x16x32_bf16 v[72:75], v[228:231], a[48:51], v[72:75]
  ds_read_b64_tr_b16 v[244:245], v13 offset:2048
  v_mfma_f32_16x16x32_bf16 v[76:79], v[228:231], a[52:55], v[76:79]
  buffer_load_dwordx4 v9, s[16:19], s78 offen offset:1024 lds
  ds_read_b64_tr_b16 v[246:247], v13 offset:3072
  s_waitcnt lgkmcnt(6)
  v_mfma_f32_16x16x32_bf16 v[80:83], v[232:235], a[48:51], v[80:83]
  ds_read_b64_tr_b16 v[248:249], v14 offset:2048
  v_mfma_f32_16x16x32_bf16 v[84:87], v[232:235], a[52:55], v[84:87]
  ds_read_b64_tr_b16 v[250:251], v14 offset:3072
  s_waitcnt lgkmcnt(6)
  v_mfma_f32_16x16x32_bf16 v[88:91], v[236:239], a[48:51], v[88:91]
  ds_read_b64_tr_b16 v[252:253], v15 offset:2048
  v_mfma_f32_16x16x32_bf16 v[92:95], v[236:239], a[52:55], v[92:95]
  ds_read_b64_tr_b16 v[254:255], v15 offset:3072
  s_waitcnt lgkmcnt(6)
  v_mfma_f32_16x16x32_bf16 v[96:99], v[240:243], a[48:51], v[96:99]
  ds_read_b64_tr_b16 v[224:225], v12 offset:8192
  v_mfma_f32_16x16x32_bf16 v[100:103], v[240:243], a[52:55], v[100:103]
  ds_read_b64_tr_b16 v[226:227], v12 offset:9216
  s_waitcnt lgkmcnt(6)
  v_mfma_f32_16x16x32_bf16 v[104:107], v[244:247], a[48:51], v[104:107]
  ds_read_b64_tr_b16 v[228:229], v13 offset:8192
  v_mfma_f32_16x16x32_bf16 v[108:111], v[244:247], a[52:55], v[108:111]
  ds_read_b64_tr_b16 v[230:231], v13 offset:9216
  s_waitcnt lgkmcnt(6)
  v_mfma_f32_16x16x32_bf16 v[112:115], v[248:251], a[48:51], v[112:115]
  ds_read_b64_tr_b16 v[232:233], v14 offset:8192
  v_mfma_f32_16x16x32_bf16 v[116:119], v[248:251], a[52:55], v[116:119]
  ds_read_b64_tr_b16 v[234:235], v14 offset:9216
  s_waitcnt lgkmcnt(6)
  v_mfma_f32_16x16x32_bf16 v[120:123], v[252:255], a[48:51], v[120:123]
  ds_read_b64_tr_b16 v[236:237], v15 offset:8192
  v_mfma_f32_16x16x32_bf16 v[124:127], v[252:255], a[52:55], v[124:127]
  ds_read_b64_tr_b16 v[238:239], v15 offset:9216
  s_waitcnt lgkmcnt(6)
  v_mfma_f32_16x16x32_bf16 v[64:67], v[224:227], a[56:59], v[64:67]
  ds_read_b64_tr_b16 v[240:241], v12 offset:10240
  v_mfma_f32_16x16x32_bf16 v[68:71], v[224:227], a[60:63], v[68:71]
  ds_read_b64_tr_b16 v[242:243], v12 offset:11264
  s_waitcnt lgkmcnt(6)
  v_mfma_f32_16x16x32_bf16 v[72:75], v[228:231], a[56:59], v[72:75]
  ds_read_b64_tr_b16 v[244:245], v13 offset:10240
  v_mfma_f32_16x16x32_bf16 v[76:79], v[228:231], a[60:63], v[76:79]
  ds_read_b64_tr_b16 v[246:247], v13 offset:11264
  s_waitcnt lgkmcnt(6)
  v_mfma_f32_16x16x32_bf16 v[80:83], v[232:235], a[56:59], v[80:83]
  ds_read_b64_tr_b16 v[248:249], v14 offset:10240
  v_mfma_f32_16x16x32_bf16 v[84:87], v[232:235], a[60:63], v[84:87]
  ds_read_b64_tr_b16 v[250:251], v14 offset:11264
  s_waitcnt lgkmcnt(6)
  v_mfma_f32_16x16x32_bf16 v[88:91], v[236:239], a[56:59], v[88:91]
  ds_read_b64_tr_b16 v[252:253], v15 offset:10240
  v_mfma_f32_16x16x32_bf16 v[92:95], v[236:239], a[60:63], v[92:95]
  ds_read_b64_tr_b16 v[254:255], v15 offset:11264
  ds_read_b128 a[64:67], v10 offset:16384
  ds_read_b128 a[68:71], v10 offset:18432
  ds_read_b128 a[72:75], v11 offset:16384
  ds_read_b128 a[76:79], v11 offset:18432
  s_waitcnt vmcnt(9)
  s_waitcnt lgkmcnt(4)
  s_barrier
  s_add_u32 m0, s65, 49152
  s_mov_b32 s78, 1376256
  buffer_load_dwordx4 v6, s[16:19], s78 offen offset:0 lds
  v_mfma_f32_16x16x32_bf16 v[96:99], v[240:243], a[56:59], v[96:99]
  ds_read_b64_tr_b16 v[224:225], v12 offset:16384
  v_mfma_f32_16x16x32_bf16 v[100:103], v[240:243], a[60:63], v[100:103]
  ds_read_b64_tr_b16 v[226:227], v12 offset:17408
  v_mfma_f32_16x16x32_bf16 v[104:107], v[244:247], a[56:59], v[104:107]
  ds_read_b64_tr_b16 v[228:229], v13 offset:16384
  v_mfma_f32_16x16x32_bf16 v[108:111], v[244:247], a[60:63], v[108:111]
  buffer_load_dwordx4 v7, s[16:19], s78 offen offset:1024 lds
  ds_read_b64_tr_b16 v[230:231], v13 offset:17408
  v_mfma_f32_16x16x32_bf16 v[112:115], v[248:251], a[56:59], v[112:115]
  ds_read_b64_tr_b16 v[232:233], v14 offset:16384
  v_mfma_f32_16x16x32_bf16 v[116:119], v[248:251], a[60:63], v[116:119]
  ds_read_b64_tr_b16 v[234:235], v14 offset:17408
  v_mfma_f32_16x16x32_bf16 v[120:123], v[252:255], a[56:59], v[120:123]
  ds_read_b64_tr_b16 v[236:237], v15 offset:16384
  s_waitcnt vmcnt(10)
L_chk0:
  v_cmp_ne_u64 vcc, v[222:223], v[52:53]
  s_and_b32 vcc_lo, vcc_lo, 0x77777777
  s_and_b32 vcc_hi, vcc_hi, 0x777777
  s_cmp_lg_u64 vcc, 0
  s_cbranch_scc1 L_spin0
L_ok0:
  s_add_u32 m0, s65, 51200
  s_nop 0
  buffer_load_dwordx4 v8, s[16:19], s78 offen offset:0 lds
  v_mfma_f32_16x16x32_bf16 v[124:127], v[252:255], a[60:63], v[124:127]
  ds_read_b64_tr_b16 v[238:239], v15 offset:17408
  s_waitcnt lgkmcnt(6)
  v_mfma_f32_16x16x32_bf16 v[64:67], v[224:227], a[64:67], v[64:67]
  ds_read_b64_tr_b16 v[240:241], v12 offset:18432
  v_mfma_f32_16x16x32_bf16 v[68:71], v[224:227], a[68:71], v[68:71]
  ds_read_b64_tr_b16 v[242:243], v12 offset:19456
  s_waitcnt lgkmcnt(6)
  v_mfma_f32_16x16x32_bf16 v[72:75], v[228:231], a[64:67], v[72:75]
  buffer_load_dwordx4 v9, s[16:19], s78 offen offset:1024 lds
  ds_read_b64_tr_b16 v[244:245], v13 offset:18432
  v_mfma_f32_16x16x32_bf16 v[76:79], v[228:231], a[68:71], v[76:79]
  ds_read_b64_tr_b16 v[246:247], v13 offset:19456
  s_waitcnt lgkmcnt(6)
  v_mfma_f32_16x16x32_bf16 v[80:83], v[232:235], a[64:67], v[80:83]
  ds_read_b64_tr_b16 v[248:249], v14 offset:18432
  v_mfma_f32_16x16x32_bf16 v[84:87], v[232:235], a[68:71], v[84:87]
  ds_read_b64_tr_b16 v[250:251], v14 offset:19456
  s_waitcnt lgkmcnt(6)
  v_mfma_f32_16x16x32_bf16 v[88:91], v[236:239], a[64:67], v[88:91]
  s_add_u32 m0, s65, 98304
  s_add_u32 s78, s65, 0
  buffer_load_dwordx4 v26, s[28:31], s78 offen offset:0 sc1 lds
  ds_read_b64_tr_b16 v[252:253], v15 offset:18432
  v_mfma_f32_16x16x32_bf16 v[92:95], v[236:239], a[68:71], v[92:95]
  ds_read_b64_tr_b16 v[254:255], v15 offset:19456
  s_waitcnt lgkmcnt(6)
  v_mfma_f32_16x16x32_bf16 v[96:99], v[240:243], a[64:67], v[96:99]
  ds_read_b64_tr_b16 v[224:225], v12 offset:24576
  v_mfma_f32_16x16x32_bf16 v[100:103], v[240:243], a[68:71], v[100:103]
  ds_read_b64_tr_b16 v[226:227], v12 offset:25600
  s_waitcnt lgkmcnt(6)
  v_mfma_f32_16x16x32_bf16 v[104:107], v[244:247], a[64:67], v[104:107]
  buffer_load_dwordx4 v26, s[28:31], s78 offen offset:1024 sc1 lds
  ds_read_b64_tr_b16 v[228:229], v13 offset:24576
  v_mfma_f32_16x16x32_bf16 v[108:111], v[244:247], a[68:71], v[108:111]
  ds_read_b64_tr_b16 v[230:231], v13 offset:25600
  s_waitcnt lgkmcnt(6)
  v_mfma_f32_16x16x32_bf16 v[112:115], v[248:251], a[64:67], v[112:115]
  ds_read_b64_tr_b16 v[232:233], v14 offset:24576
  v_mfma_f32_16x16x32_bf16 v[116:119], v[248:251], a[68:71], v[116:119]
  ds_read_b64_tr_b16 v[234:235], v14 offset:25600
  s_waitcnt lgkmcnt(6)
  v_mfma_f32_16x16x32_bf16 v[120:123], v[252:255], a[64:67], v[120:123]
  buffer_load_dwordx4 v26, s[28:31], s78 offen offset:2048 sc1 lds
  ds_read_b64_tr_b16 v[236:237], v15 offset:24576
  v_mfma_f32_16x16x32_bf16 v[124:127], v[252:255], a[68:71], v[124:127]
  ds_read_b64_tr_b16 v[238:239], v15 offset:25600
  s_waitcnt lgkmcnt(6)
  v_mfma_f32_16x16x32_bf16 v[64:67], v[224:227], a[72:75], v[64:67]
  ds_read_b64_tr_b16 v[240:241], v12 offset:26624
  v_mfma_f32_16x16x32_bf16 v[68:71], v[224:227], a[76:79], v[68:71]
  ds_read_b64_tr_b16 v[242:243], v12 offset:27648
  s_waitcnt lgkmcnt(6)
  v_mfma_f32_16x16x32_bf16 v[72:75], v[228:231], a[72:75], v[72:75]
  buffer_load_dwordx4 v26, s[28:31], s78 offen offset:3072 sc1 lds
  ds_read_b64_tr_b16 v[244:245], v13 offset:26624
  v_mfma_f32_16x16x32_bf16 v[76:79], v[228:231], a[76:79], v[76:79]
  ds_read_b64_tr_b16 v[246:247], v13 offset:27648
  s_waitcnt lgkmcnt(6)
  v_mfma_f32_16x16x32_bf16 v[80:83], v[232:235], a[72:75], v[80:83]
  ds_read_b64_tr_b16 v[248:249], v14 offset:26624
  v_mfma_f32_16x16x32_bf16 v[84:87], v[232:235], a[76:79], v[84:87]
  ds_read_b64_tr_b16 v[250:251], v14 offset:27648
  s_waitcnt lgkmcnt(6)
  v_mfma_f32_16x16x32_bf16 v[88:91], v[236:239], a[72:75], v[88:91]
  s_add_u32 m0, s65, 114688
  s_add_u32 s78, s65, 16384
  buffer_load_dwordx4 v26, s[28:31], s78 offen offset:0 sc1 lds
  ds_read_b64_tr_b16 v[252:253], v15 offset:26624
  v_mfma_f32_16x16x32_bf16 v[92:95], v[236:239], a[76:79], v[92:95]
  ds_read_b64_tr_b16 v[254:255], v15 offset:27648
  ds_read_b128 a[80:83], v10 offset:32768
  ds_read_b128 a[84:87], v10 offset:34816
  ds_read_b128 a[88:91], v11 offset:32768
  ds_read_b128 a[92:95], v11 offset:34816
  buffer_load_dwordx4 v26, s[28:31], s78 offen offset:1024 sc1 lds
  buffer_load_dwordx4 v26, s[28:31], s78 offen offset:2048 sc1 lds
  buffer_load_dwordx4 v26, s[28:31], s78 offen offset:3072 sc1 lds
  s_waitcnt vmcnt(12)
  s_waitcnt lgkmcnt(4)
  s_barrier
  s_add_u32 m0, s65, 131072
  s_add_u32 s78, s65, 32768
  buffer_load_dwordx4 v26, s[28:31], s78 offen offset:0 sc1 lds
  v_mfma_f32_16x16x32_bf16 v[96:99], v[240:243], a[72:75], v[96:99]
  ds_read_b64_tr_b16 v[224:225], v12 offset:32768
  v_mfma_f32_16x16x32_bf16 v[100:103], v[240:243], a[76:79], v[100:103]
  ds_read_b64_tr_b16 v[226:227], v12 offset:33792
  v_mfma_f32_16x16x32_bf16 v[104:107], v[244:247], a[72:75], v[104:107]
  ds_read_b64_tr_b16 v[228:229], v13 offset:32768
  v_mfma_f32_16x16x32_bf16 v[108:111], v[244:247], a[76:79], v[108:111]
  buffer_load_dwordx4 v26, s[28:31], s78 offen offset:1024 sc1 lds
  ds_read_b64_tr_b16 v[230:231], v13 offset:33792
  v_mfma_f32_16x16x32_bf16 v[112:115], v[248:251], a[72:75], v[112:115]
  ds_read_b64_tr_b16 v[232:233], v14 offset:32768
  v_mfma_f32_16x16x32_bf16 v[116:119], v[248:251], a[76:79], v[116:119]
  ds_read_b64_tr_b16 v[234:235], v14 offset:33792
  v_mfma_f32_16x16x32_bf16 v[120:123], v[252:255], a[72:75], v[120:123]
  ds_read_b64_tr_b16 v[236:237], v15 offset:32768
  v_mfma_f32_16x16x32_bf16 v[124:127], v[252:255], a[76:79], v[124:127]
  buffer_load_dwordx4 v26, s[28:31], s78 offen offset:2048 sc1 lds
  ds_read_b64_tr_b16 v[238:239], v15 offset:33792
  s_waitcnt lgkmcnt(6)
  v_mfma_f32_16x16x32_bf16 v[64:67], v[224:227], a[80:83], v[64:67]
  ds_read_b64_tr_b16 v[240:241], v12 offset:34816
  v_mfma_f32_16x16x32_bf16 v[68:71], v[224:227], a[84:87], v[68:71]
  ds_read_b64_tr_b16 v[242:243], v12 offset:35840
  s_waitcnt lgkmcnt(6)
  v_mfma_f32_16x16x32_bf16 v[72:75], v[228:231], a[80:83], v[72:75]
  ds_read_b64_tr_b16 v[244:245], v13 offset:34816
  v_mfma_f32_16x16x32_bf16 v[76:79], v[228:231], a[84:87], v[76:79]
  buffer_load_dwordx4 v26, s[28:31], s78 offen offset:3072 sc1 lds
  ds_read_b64_tr_b16 v[246:247], v13 offset:35840
  s_waitcnt lgkmcnt(6)
  v_mfma_f32_16x16x32_bf16 v[80:83], v[232:235], a[80:83], v[80:83]
  ds_read_b64_tr_b16 v[248:249], v14 offset:34816
  v_mfma_f32_16x16x32_bf16 v[84:87], v[232:235], a[84:87], v[84:87]
  ds_read_b64_tr_b16 v[250:251], v14 offset:35840
  s_waitcnt lgkmcnt(6)
  v_mfma_f32_16x16x32_bf16 v[88:91], v[236:239], a[80:83], v[88:91]
  ds_read_b64_tr_b16 v[252:253], v15 offset:34816
  v_mfma_f32_16x16x32_bf16 v[92:95], v[236:239], a[84:87], v[92:95]
  ds_read_b64_tr_b16 v[254:255], v15 offset:35840
  s_waitcnt lgkmcnt(6)
  v_mfma_f32_16x16x32_bf16 v[96:99], v[240:243], a[80:83], v[96:99]
  ds_read_b64_tr_b16 v[224:225], v12 offset:40960
  v_mfma_f32_16x16x32_bf16 v[100:103], v[240:243], a[84:87], v[100:103]
  ds_read_b64_tr_b16 v[226:227], v12 offset:41984
  s_waitcnt lgkmcnt(6)
  v_mfma_f32_16x16x32_bf16 v[104:107], v[244:247], a[80:83], v[104:107]
  ds_read_b64_tr_b16 v[228:229], v13 offset:40960
  v_mfma_f32_16x16x32_bf16 v[108:111], v[244:247], a[84:87], v[108:111]
  ds_read_b64_tr_b16 v[230:231], v13 offset:41984
  s_waitcnt lgkmcnt(6)
  v_mfma_f32_16x16x32_bf16 v[112:115], v[248:251], a[80:83], v[112:115]
  ds_read_b64_tr_b16 v[232:233], v14 offset:40960
  v_mfma_f32_16x16x32_bf16 v[116:119], v[248:251], a[84:87], v[116:119]
  ds_read_b64_tr_b16 v[234:235], v14 offset:41984
  s_waitcnt lgkmcnt(6)
  v_mfma_f32_16x16x32_bf16 v[120:123], v[252:255], a[80:83], v[120:123]
  ds_read_b64_tr_b16 v[236:237], v15 offset:40960
  v_mfma_f32_16x16x32_bf16 v[124:127], v[252:255], a[84:87], v[124:127]
  ds_read_b64_tr_b16 v[238:239], v15 offset:41984
  s_waitcnt lgkmcnt(6)
  v_mfma_f32_16x16x32_bf16 v[64:67], v[224:227], a[88:91], v[64:67]
  ds_read_b64_tr_b16 v[240:241], v12 offset:43008
  v_mfma_f32_16x16x32_bf16 v[68:71], v[224:227], a[92:95], v[68:71]
  ds_read_b64_tr_b16 v[242:243], v12 offset:44032
  s_waitcnt lgkmcnt(6)
  v_mfma_f32_16x16x32_bf16 v[72:75], v[228:231], a[88:91], v[72:75]
  ds_read_b64_tr_b16 v[244:245], v13 offset:43008
  v_mfma_f32_16x16x32_bf16 v[76:79], v[228:231], a[92:95], v[76:79]
  ds_read_b64_tr_b16 v[246:247], v13 offset:44032
  s_waitcnt lgkmcnt(6)
  v_mfma_f32_16x16x32_bf16 v[80:83], v[232:235], a[88:91], v[80:83]
  ds_read_b64_tr_b16 v[248:249], v14 offset:43008
  v_mfma_f32_16x16x32_bf16 v[84:87], v[232:235], a[92:95], v[84:87]
  ds_read_b64_tr_b16 v[250:251], v14 offset:44032
  s_waitcnt lgkmcnt(6)
  v_mfma_f32_16x16x32_bf16 v[88:91], v[236:239], a[88:91], v[88:91]
  ds_read_b64_tr_b16 v[252:253], v15 offset:43008
  v_mfma_f32_16x16x32_bf16 v[92:95], v[236:239], a[92:95], v[92:95]
  ds_read_b64_tr_b16 v[254:255], v15 offset:44032
  ds_read_b128 a[96:99], v10 offset:0
  ds_read_b128 a[100:103], v10 offset:2048
  ds_read_b128 a[104:107], v11 offset:0
  ds_read_b128 a[108:111], v11 offset:2048
  s_lshr_b32 s78, s65, 1
  s_add_u32 m0, s78, 147456
  s_add_u32 s78, s78, 49152
  buffer_load_dwordx4 v26, s[28:31], s78 offen offset:0 sc1 lds
  buffer_load_dwordx4 v26, s[28:31], s78 offen offset:1024 sc1 lds
  s_add_u32 m0, s65, 16384
  s_add_u32 s78, s65, 57344
  buffer_load_dwordx4 v26, s[28:31], s78 offen offset:0 sc1 lds
  s_waitcnt vmcnt(15)
  buffer_load_dwordx4 v26, s[28:31], s78 offen offset:1024 sc1 lds
  s_waitcnt lgkmcnt(4)
  s_barrier
  v_mfma_f32_16x16x32_bf16 v[96:99], v[240:243], a[88:91], v[96:99]
  ds_read_b64_tr_b16 v[224:225], v12 offset:0
  v_mfma_f32_16x16x32_bf16 v[100:103], v[240:243], a[92:95], v[100:103]
  ds_read_b64_tr_b16 v[226:227], v12 offset:1024
  v_mfma_f32_16x16x32_bf16 v[104:107], v[244:247], a[88:91], v[104:107]
  ds_read_b64_tr_b16 v[228:229], v13 offset:0
  v_mfma_f32_16x16x32_bf16 v[108:111], v[244:247], a[92:95], v[108:111]
  ds_read_b64_tr_b16 v[230:231], v13 offset:1024
  v_mfma_f32_16x16x32_bf16 v[112:115], v[248:251], a[88:91], v[112:115]
  ds_read_b64_tr_b16 v[232:233], v14 offset:0
  v_mfma_f32_16x16x32_bf16 v[116:119], v[248:251], a[92:95], v[116:119]
  ds_read_b64_tr_b16 v[234:235], v14 offset:1024
  v_mfma_f32_16x16x32_bf16 v[120:123], v[252:255], a[88:91], v[120:123]
  ds_read_b64_tr_b16 v[236:237], v15 offset:0
  v_mfma_f32_16x16x32_bf16 v[124:127], v[252:255], a[92:95], v[124:127]
  buffer_load_dwordx4 v26, s[28:31], s78 offen offset:2048 sc1 lds
  ds_read_b64_tr_b16 v[238:239], v15 offset:1024
  s_waitcnt lgkmcnt(6)
  v_mfma_f32_16x16x32_bf16 v[64:67], v[224:227], a[96:99], v[64:67]
  ds_read_b64_tr_b16 v[240:241], v12 offset:2048
  v_mfma_f32_16x16x32_bf16 v[68:71], v[224:227], a[100:103], v[68:71]
  ds_read_b64_tr_b16 v[242:243], v12 offset:3072
  s_waitcnt lgkmcnt(6)
  v_mfma_f32_16x16x32_bf16 v[72:75], v[228:231], a[96:99], v[72:75]
  ds_read_b64_tr_b16 v[244:245], v13 offset:2048
  v_mfma_f32_16x16x32_bf16 v[76:79], v[228:231], a[100:103], v[76:79]
  buffer_load_dwordx4 v26, s[28:31], s78 offen offset:3072 sc1 lds
  ds_read_b64_tr_b16 v[246:247], v13 offset:3072
  s_waitcnt lgkmcnt(6)
  v_mfma_f32_16x16x32_bf16 v[80:83], v[232:235], a[96:99], v[80:83]
  ds_read_b64_tr_b16 v[248:249], v14 offset:2048
  v_mfma_f32_16x16x32_bf16 v[84:87], v[232:235], a[100:103], v[84:87]
  ds_read_b64_tr_b16 v[250:251], v14 offset:3072
  s_waitcnt lgkmcnt(6)
  v_mfma_f32_16x16x32_bf16 v[88:91], v[236:239], a[96:99], v[88:91]
  ds_read_b64_tr_b16 v[252:253], v15 offset:2048
  v_mfma_f32_16x16x32_bf16 v[92:95], v[236:239], a[100:103], v[92:95]
  s_add_u32 m0, s65, 32768
  s_mul_i32 s78, s46, 3072
  s_add_u32 s78, s78, 73728
  buffer_load_dwordx4 v26, s[28:31], s78 offen offset:0 sc1 lds
  ds_read_b64_tr_b16 v[254:255], v15 offset:3072
  s_waitcnt lgkmcnt(6)
  v_mfma_f32_16x16x32_bf16 v[96:99], v[240:243], a[96:99], v[96:99]
  ds_read_b64_tr_b16 v[224:225], v12 offset:8192
  v_mfma_f32_16x16x32_bf16 v[100:103], v[240:243], a[100:103], v[100:103]
  ds_read_b64_tr_b16 v[226:227], v12 offset:9216
  s_waitcnt lgkmcnt(6)
  v_mfma_f32_16x16x32_bf16 v[104:107], v[244:247], a[96:99], v[104:107]
  ds_read_b64_tr_b16 v[228:229], v13 offset:8192
  v_mfma_f32_16x16x32_bf16 v[108:111], v[244:247], a[100:103], v[108:111]
  buffer_load_dwordx4 v26, s[28:31], s78 offen offset:1024 sc1 lds
  ds_read_b64_tr_b16 v[230:231], v13 offset:9216
  s_waitcnt lgkmcnt(6)
  v_mfma_f32_16x16x32_bf16 v[112:115], v[248:251], a[96:99], v[112:115]
  ds_read_b64_tr_b16 v[232:233], v14 offset:8192
  v_mfma_f32_16x16x32_bf16 v[116:119], v[248:251], a[100:103], v[116:119]
  ds_read_b64_tr_b16 v[234:235], v14 offset:9216
  s_waitcnt lgkmcnt(6)
  v_mfma_f32_16x16x32_bf16 v[120:123], v[252:255], a[96:99], v[120:123]
  ds_read_b64_tr_b16 v[236:237], v15 offset:8192
  v_mfma_f32_16x16x32_bf16 v[124:127], v[252:255], a[100:103], v[124:127]
  buffer_load_dwordx4 v26, s[28:31], s78 offen offset:2048 sc1 lds
  ds_read_b64_tr_b16 v[238:239], v15 offset:9216
  s_waitcnt lgkmcnt(6)
  v_mfma_f32_16x16x32_bf16 v[64:67], v[224:227], a[104:107], v[64:67]
  ds_read_b64_tr_b16 v[240:241], v12 offset:10240
  v_mfma_f32_16x16x32_bf16 v[68:71], v[224:227], a[108:111], v[68:71]
  ds_read_b64_tr_b16 v[242:243], v12 offset:11264
  s_waitcnt lgkmcnt(6)
  v_mfma_f32_16x16x32_bf16 v[72:75], v[228:231], a[104:107], v[72:75]
  ds_read_b64_tr_b16 v[244:245], v13 offset:10240
  v_mfma_f32_16x16x32_bf16 v[76:79], v[228:231], a[108:111], v[76:79]
  s_add_u32 s75, s46, 0
  v_readlane_b32 s79, v22, s75
  s_add_u32 m0, s65, 65536
  s_nop 3
  buffer_load_dwordx4 v32, s[20:23], s79 offen offset:0 lds
  ds_read_b64_tr_b16 v[246:247], v13 offset:11264
  s_waitcnt lgkmcnt(6)
  v_mfma_f32_16x16x32_bf16 v[80:83], v[232:235], a[104:107], v[80:83]
  ds_read_b64_tr_b16 v[248:249], v14 offset:10240
  v_mfma_f32_16x16x32_bf16 v[84:87], v[232:235], a[108:111], v[84:87]
  ds_read_b64_tr_b16 v[250:251], v14 offset:11264
  s_waitcnt lgkmcnt(6)
  v_mfma_f32_16x16x32_bf16 v[88:91], v[236:239], a[104:107], v[88:91]
  ds_read_b64_tr_b16 v[252:253], v15 offset:10240
  v_mfma_f32_16x16x32_bf16 v[92:95], v[236:239], a[108:111], v[92:95]
  buffer_load_dwordx4 v33, s[20:23], s79 offen offset:1024 lds
  ds_read_b64_tr_b16 v[254:255], v15 offset:11264
  s_waitcnt lgkmcnt(6)
  v_mfma_f32_16x16x32_bf16 v[96:99], v[240:243], a[104:107], v[96:99]
  v_mfma_f32_16x16x32_bf16 v[100:103], v[240:243], a[108:111], v[100:103]
  s_waitcnt lgkmcnt(4)
  v_mfma_f32_16x16x32_bf16 v[104:107], v[244:247], a[104:107], v[104:107]
  v_mfma_f32_16x16x32_bf16 v[108:111], v[244:247], a[108:111], v[108:111]
  buffer_load_dwordx4 v34, s[20:23], s79 offen offset:2048 lds
  s_waitcnt lgkmcnt(2)
  v_mfma_f32_16x16x32_bf16 v[112:115], v[248:251], a[104:107], v[112:115]
  v_mfma_f32_16x16x32_bf16 v[116:119], v[248:251], a[108:111], v[116:119]
  s_waitcnt lgkmcnt(0)
  v_mfma_f32_16x16x32_bf16 v[120:123], v[252:255], a[104:107], v[120:123]
  v_mfma_f32_16x16x32_bf16 v[124:127], v[252:255], a[108:111], v[124:127]
  buffer_load_dwordx4 v35, s[20:23], s79 offen offset:3072 lds
  v_pk_fma_f32 v[128:129], v[64:65], s[60:61], -0.5 op_sel_hi:[1,0,0]
  v_pk_fma_f32 v[130:131], v[66:67], s[60:61], -0.5 op_sel_hi:[1,0,0]
  v_pk_fma_f32 v[132:133], v[68:69], s[60:61], -0.5 op_sel_hi:[1,0,0]
  v_pk_fma_f32 v[134:135], v[70:71], s[60:61], -0.5 op_sel_hi:[1,0,0]
  v_pk_fma_f32 v[136:137], v[72:73], s[60:61], -0.5 op_sel_hi:[1,0,0]
  v_pk_fma_f32 v[138:139], v[74:75], s[60:61], -0.5 op_sel_hi:[1,0,0]
  v_pk_fma_f32 v[140:141], v[76:77], s[60:61], -0.5 op_sel_hi:[1,0,0]
  v_pk_fma_f32 v[142:143], v[78:79], s[60:61], -0.5 op_sel_hi:[1,0,0]
  v_exp_f32 v128, v128
  v_exp_f32 v129, v129
  v_exp_f32 v130, v130
  s_add_u32 s75, s46, 4
  v_readlane_b32 s79, v22, s75
  s_add_u32 m0, s65, 81920
  s_nop 3
  buffer_load_dwordx4 v32, s[20:23], s79 offen offset:0 lds
  v_exp_f32 v131, v131
  v_exp_f32 v132, v132
  v_exp_f32 v133, v133
  v_exp_f32 v134, v134
  v_exp_f32 v135, v135
  v_exp_f32 v136, v136
  v_exp_f32 v137, v137
  buffer_load_dwordx4 v33, s[20:23], s79 offen offset:1024 lds
  v_exp_f32 v138, v138
  v_exp_f32 v139, v139
  v_exp_f32 v140, v140
  v_exp_f32 v141, v141
  v_exp_f32 v142, v142
  v_exp_f32 v143, v143
  v_pk_add_f32 v[128:129], v[128:129], s[60:61] op_sel:[0,1] op_sel_hi:[1,1]
  v_pk_add_f32 v[130:131], v[130:131], s[60:61] op_sel:[0,1] op_sel_hi:[1,1]
  buffer_load_dwordx4 v34, s[20:23], s79 offen offset:2048 lds
  v_pk_add_f32 v[132:133], v[132:133], s[60:61] op_sel:[0,1] op_sel_hi:[1,1]
  v_pk_add_f32 v[134:135], v[134:135], s[60:61] op_sel:[0,1] op_sel_hi:[1,1]
  v_pk_add_f32 v[136:137], v[136:137], s[60:61] op_sel:[0,1] op_sel_hi:[1,1]
  v_pk_add_f32 v[138:139], v[138:139], s[60:61] op_sel:[0,1] op_sel_hi:[1,1]
  v_pk_add_f32 v[140:141], v[140:141], s[60:61] op_sel:[0,1] op_sel_hi:[1,1]
  v_pk_add_f32 v[142:143], v[142:143], s[60:61] op_sel:[0,1] op_sel_hi:[1,1]
  v_pk_fma_f32 v[128:129], v[128:129], v[128:129], 0.5 op_sel_hi:[1,1,0]
  v_pk_fma_f32 v[130:131], v[130:131], v[130:131], 0.5 op_sel_hi:[1,1,0]
  v_pk_fma_f32 v[132:133], v[132:133], v[132:133], 0.5 op_sel_hi:[1,1,0]
  v_pk_fma_f32 v[134:135], v[134:135], v[134:135], 0.5 op_sel_hi:[1,1,0]
  v_pk_fma_f32 v[136:137], v[136:137], v[136:137], 0.5 op_sel_hi:[1,1,0]
  v_pk_fma_f32 v[138:139], v[138:139], v[138:139], 0.5 op_sel_hi:[1,1,0]
  v_pk_fma_f32 v[140:141], v[140:141], v[140:141], 0.5 op_sel_hi:[1,1,0]
  v_pk_fma_f32 v[142:143], v[142:143], v[142:143], 0.5 op_sel_hi:[1,1,0]
  v_rcp_f32 v128, v128
  v_rcp_f32 v129, v129
  v_rcp_f32 v130, v130
  v_rcp_f32 v131, v131
  v_rcp_f32 v132, v132
  v_rcp_f32 v133, v133
  v_rcp_f32 v134, v134
  v_rcp_f32 v135, v135
  v_rcp_f32 v136, v136
  v_rcp_f32 v137, v137
  v_rcp_f32 v138, v138
  v_rcp_f32 v139, v139
  v_rcp_f32 v140, v140
  v_rcp_f32 v141, v141
  v_rcp_f32 v142, v142
  v_rcp_f32 v143, v143
  v_pk_fma_f32 v[128:129], v[64:65], v[128:129], v[64:65] neg_lo:[1,0,0] neg_hi:[1,0,0]
  v_pk_fma_f32 v[130:131], v[66:67], v[130:131], v[66:67] neg_lo:[1,0,0] neg_hi:[1,0,0]
  v_pk_fma_f32 v[132:133], v[68:69], v[132:133], v[68:69] neg_lo:[1,0,0] neg_hi:[1,0,0]
  v_pk_fma_f32 v[134:135], v[70:71], v[134:135], v[70:71] neg_lo:[1,0,0] neg_hi:[1,0,0]
  v_pk_fma_f32 v[136:137], v[72:73], v[136:137], v[72:73] neg_lo:[1,0,0] neg_hi:[1,0,0]
  v_pk_fma_f32 v[138:139], v[74:75], v[138:139], v[74:75] neg_lo:[1,0,0] neg_hi:[1,0,0]
  v_pk_fma_f32 v[140:141], v[76:77], v[140:141], v[76:77] neg_lo:[1,0,0] neg_hi:[1,0,0]
  v_pk_fma_f32 v[142:143], v[78:79], v[142:143], v[78:79] neg_lo:[1,0,0] neg_hi:[1,0,0]
  v_cvt_pk_bf16_f32 v64, v128, v129
  v_cvt_pk_bf16_f32 v65, v130, v131
  v_cvt_pk_bf16_f32 v66, v136, v137
  v_cvt_pk_bf16_f32 v67, v138, v139
  v_cvt_pk_bf16_f32 v68, v132, v133
  v_cvt_pk_bf16_f32 v69, v134, v135
  v_cvt_pk_bf16_f32 v70, v140, v141
  v_cvt_pk_bf16_f32 v71, v142, v143
  v_pk_fma_f32 v[144:145], v[80:81], s[60:61], -0.5 op_sel_hi:[1,0,0]
  v_pk_fma_f32 v[146:147], v[82:83], s[60:61], -0.5 op_sel_hi:[1,0,0]
  v_pk_fma_f32 v[148:149], v[84:85], s[60:61], -0.5 op_sel_hi:[1,0,0]
  v_pk_fma_f32 v[150:151], v[86:87], s[60:61], -0.5 op_sel_hi:[1,0,0]
  v_pk_fma_f32 v[152:153], v[88:89], s[60:61], -0.5 op_sel_hi:[1,0,0]
  v_pk_fma_f32 v[154:155], v[90:91], s[60:61], -0.5 op_sel_hi:[1,0,0]
  v_pk_fma_f32 v[156:157], v[92:93], s[60:61], -0.5 op_sel_hi:[1,0,0]
  v_pk_fma_f32 v[158:159], v[94:95], s[60:61], -0.5 op_sel_hi:[1,0,0]
  v_exp_f32 v144, v144
  v_exp_f32 v145, v145
  v_exp_f32 v146, v146
  v_exp_f32 v147, v147
  v_exp_f32 v148, v148
  v_exp_f32 v149, v149
  v_exp_f32 v150, v150
  v_exp_f32 v151, v151
  buffer_store_dwordx4 v[64:67], v27, s[28:31], s70 offen offset:0 sc1
  v_exp_f32 v152, v152
  v_exp_f32 v153, v153
  v_exp_f32 v154, v154
  v_exp_f32 v155, v155
  v_exp_f32 v156, v156
  v_exp_f32 v157, v157
  v_exp_f32 v158, v158
  v_exp_f32 v159, v159
  buffer_store_dwordx4 v[68:71], v28, s[28:31], s70 offen offset:0 sc1
  v_pk_add_f32 v[144:145], v[144:145], s[60:61] op_sel:[0,1] op_sel_hi:[1,1]
  v_pk_add_f32 v[146:147], v[146:147], s[60:61] op_sel:[0,1] op_sel_hi:[1,1]
  v_pk_add_f32 v[148:149], v[148:149], s[60:61] op_sel:[0,1] op_sel_hi:[1,1]
  v_pk_add_f32 v[150:151], v[150:151], s[60:61] op_sel:[0,1] op_sel_hi:[1,1]
  v_pk_add_f32 v[152:153], v[152:153], s[60:61] op_sel:[0,1] op_sel_hi:[1,1]
  v_pk_add_f32 v[154:155], v[154:155], s[60:61] op_sel:[0,1] op_sel_hi:[1,1]
  v_pk_add_f32 v[156:157], v[156:157], s[60:61] op_sel:[0,1] op_sel_hi:[1,1]
  v_pk_add_f32 v[158:159], v[158:159], s[60:61] op_sel:[0,1] op_sel_hi:[1,1]
  v_pk_fma_f32 v[144:145], v[144:145], v[144:145], 0.5 op_sel_hi:[1,1,0]
  v_pk_fma_f32 v[146:147], v[146:147], v[146:147], 0.5 op_sel_hi:[1,1,0]
  v_pk_fma_f32 v[148:149], v[148:149], v[148:149], 0.5 op_sel_hi:[1,1,0]
  v_pk_fma_f32 v[150:151], v[150:151], v[150:151], 0.5 op_sel_hi:[1,1,0]
  v_pk_fma_f32 v[152:153], v[152:153], v[152:153], 0.5 op_sel_hi:[1,1,0]
  v_pk_fma_f32 v[154:155], v[154:155], v[154:155], 0.5 op_sel_hi:[1,1,0]
  v_pk_fma_f32 v[156:157], v[156:157], v[156:157], 0.5 op_sel_hi:[1,1,0]
  v_pk_fma_f32 v[158:159], v[158:159], v[158:159], 0.5 op_sel_hi:[1,1,0]
  v_rcp_f32 v144, v144
  v_rcp_f32 v145, v145
  v_rcp_f32 v146, v146
  buffer_load_dwordx4 v35, s[20:23], s79 offen offset:3072 lds
  v_rcp_f32 v147, v147
  v_rcp_f32 v148, v148
  v_rcp_f32 v149, v149
  v_rcp_f32 v150, v150
  v_rcp_f32 v151, v151
  v_rcp_f32 v152, v152
  v_rcp_f32 v153, v153
  v_rcp_f32 v154, v154
  v_rcp_f32 v155, v155
  v_rcp_f32 v156, v156
  v_rcp_f32 v157, v157
  v_rcp_f32 v158, v158
  v_rcp_f32 v159, v159
  v_pk_fma_f32 v[144:145], v[80:81], v[144:145], v[80:81] neg_lo:[1,0,0] neg_hi:[1,0,0]
  v_pk_fma_f32 v[146:147], v[82:83], v[146:147], v[82:83] neg_lo:[1,0,0] neg_hi:[1,0,0]
  v_pk_fma_f32 v[148:149], v[84:85], v[148:149], v[84:85] neg_lo:[1,0,0] neg_hi:[1,0,0]
  v_pk_fma_f32 v[150:151], v[86:87], v[150:151], v[86:87] neg_lo:[1,0,0] neg_hi:[1,0,0]
  v_pk_fma_f32 v[152:153], v[88:89], v[152:153], v[88:89] neg_lo:[1,0,0] neg_hi:[1,0,0]
  v_pk_fma_f32 v[154:155], v[90:91], v[154:155], v[90:91] neg_lo:[1,0,0] neg_hi:[1,0,0]
  v_pk_fma_f32 v[156:157], v[92:93], v[156:157], v[92:93] neg_lo:[1,0,0] neg_hi:[1,0,0]
  v_pk_fma_f32 v[158:159], v[94:95], v[158:159], v[94:95] neg_lo:[1,0,0] neg_hi:[1,0,0]
  v_cvt_pk_bf16_f32 v80, v144, v145
  v_cvt_pk_bf16_f32 v81, v146, v147
  v_cvt_pk_bf16_f32 v82, v152, v153
  v_cvt_pk_bf16_f32 v83, v154, v155
  buffer_store_dwordx4 v[80:83], v27, s[28:31], s71 offen offset:0 sc1
  v_cvt_pk_bf16_f32 v84, v148, v149
  v_cvt_pk_bf16_f32 v85, v150, v151
  v_cvt_pk_bf16_f32 v86, v156, v157
  v_cvt_pk_bf16_f32 v87, v158, v159
  v_pk_fma_f32 v[128:129], v[96:97], s[60:61], -0.5 op_sel_hi:[1,0,0]
  v_pk_fma_f32 v[130:131], v[98:99], s[60:61], -0.5 op_sel_hi:[1,0,0]
  v_pk_fma_f32 v[132:133], v[100:101], s[60:61], -0.5 op_sel_hi:[1,0,0]
  v_pk_fma_f32 v[134:135], v[102:103], s[60:61], -0.5 op_sel_hi:[1,0,0]
  v_pk_fma_f32 v[136:137], v[104:105], s[60:61], -0.5 op_sel_hi:[1,0,0]
  v_pk_fma_f32 v[138:139], v[106:107], s[60:61], -0.5 op_sel_hi:[1,0,0]
  v_pk_fma_f32 v[140:141], v[108:109], s[60:61], -0.5 op_sel_hi:[1,0,0]
  v_pk_fma_f32 v[142:143], v[110:111], s[60:61], -0.5 op_sel_hi:[1,0,0]
  v_exp_f32 v128, v128
  v_exp_f32 v129, v129
  buffer_store_dwordx4 v[84:87], v28, s[28:31], s71 offen offset:0 sc1
  v_exp_f32 v130, v130
  v_exp_f32 v131, v131
  v_exp_f32 v132, v132
  v_exp_f32 v133, v133
  v_exp_f32 v134, v134
  v_exp_f32 v135, v135
  v_exp_f32 v136, v136
  v_exp_f32 v137, v137
  v_exp_f32 v138, v138
  v_exp_f32 v139, v139
  v_exp_f32 v140, v140
  v_exp_f32 v141, v141
  v_exp_f32 v142, v142
  v_exp_f32 v143, v143
  v_pk_add_f32 v[128:129], v[128:129], s[60:61] op_sel:[0,1] op_sel_hi:[1,1]
  v_pk_add_f32 v[130:131], v[130:131], s[60:61] op_sel:[0,1] op_sel_hi:[1,1]
  v_pk_add_f32 v[132:133], v[132:133], s[60:61] op_sel:[0,1] op_sel_hi:[1,1]
  v_pk_add_f32 v[134:135], v[134:135], s[60:61] op_sel:[0,1] op_sel_hi:[1,1]
  v_pk_add_f32 v[136:137], v[136:137], s[60:61] op_sel:[0,1] op_sel_hi:[1,1]
  v_pk_add_f32 v[138:139], v[138:139], s[60:61] op_sel:[0,1] op_sel_hi:[1,1]
  v_pk_add_f32 v[140:141], v[140:141], s[60:61] op_sel:[0,1] op_sel_hi:[1,1]
  v_pk_add_f32 v[142:143], v[142:143], s[60:61] op_sel:[0,1] op_sel_hi:[1,1]
  v_pk_fma_f32 v[128:129], v[128:129], v[128:129], 0.5 op_sel_hi:[1,1,0]
  v_pk_fma_f32 v[130:131], v[130:131], v[130:131], 0.5 op_sel_hi:[1,1,0]
  v_pk_fma_f32 v[132:133], v[132:133], v[132:133], 0.5 op_sel_hi:[1,1,0]
  v_pk_fma_f32 v[134:135], v[134:135], v[134:135], 0.5 op_sel_hi:[1,1,0]
  v_pk_fma_f32 v[136:137], v[136:137], v[136:137], 0.5 op_sel_hi:[1,1,0]
  v_pk_fma_f32 v[138:139], v[138:139], v[138:139], 0.5 op_sel_hi:[1,1,0]
  v_pk_fma_f32 v[140:141], v[140:141], v[140:141], 0.5 op_sel_hi:[1,1,0]
  v_pk_fma_f32 v[142:143], v[142:143], v[142:143], 0.5 op_sel_hi:[1,1,0]
  v_rcp_f32 v128, v128
  v_rcp_f32 v129, v129
  v_rcp_f32 v130, v130
  v_rcp_f32 v131, v131
  v_rcp_f32 v132, v132
  v_rcp_f32 v133, v133
  v_rcp_f32 v134, v134
  v_rcp_f32 v135, v135
  v_rcp_f32 v136, v136
  v_rcp_f32 v137, v137
  v_rcp_f32 v138, v138
  v_rcp_f32 v139, v139
  v_rcp_f32 v140, v140
  v_rcp_f32 v141, v141
  v_rcp_f32 v142, v142
  v_rcp_f32 v143, v143
  v_pk_fma_f32 v[128:129], v[96:97], v[128:129], v[96:97] neg_lo:[1,0,0] neg_hi:[1,0,0]
  v_pk_fma_f32 v[130:131], v[98:99], v[130:131], v[98:99] neg_lo:[1,0,0] neg_hi:[1,0,0]
  v_pk_fma_f32 v[132:133], v[100:101], v[132:133], v[100:101] neg_lo:[1,0,0] neg_hi:[1,0,0]
  v_pk_fma_f32 v[134:135], v[102:103], v[134:135], v[102:103] neg_lo:[1,0,0] neg_hi:[1,0,0]
  v_pk_fma_f32 v[136:137], v[104:105], v[136:137], v[104:105] neg_lo:[1,0,0] neg_hi:[1,0,0]
  v_pk_fma_f32 v[138:139], v[106:107], v[138:139], v[106:107] neg_lo:[1,0,0] neg_hi:[1,0,0]
  v_pk_fma_f32 v[140:141], v[108:109], v[140:141], v[108:109] neg_lo:[1,0,0] neg_hi:[1,0,0]
  v_pk_fma_f32 v[142:143], v[110:111], v[142:143], v[110:111] neg_lo:[1,0,0] neg_hi:[1,0,0]
  v_cvt_pk_bf16_f32 v96, v128, v129
  v_cvt_pk_bf16_f32 v97, v130, v131
  v_cvt_pk_bf16_f32 v98, v136, v137
  v_cvt_pk_bf16_f32 v99, v138, v139
  buffer_store_dwordx4 v[96:99], v27, s[28:31], s72 offen offset:0 sc1
  v_cvt_pk_bf16_f32 v100, v132, v133
  v_cvt_pk_bf16_f32 v101, v134, v135
  v_cvt_pk_bf16_f32 v102, v140, v141
  v_cvt_pk_bf16_f32 v103, v142, v143
  v_pk_fma_f32 v[144:145], v[112:113], s[60:61], -0.5 op_sel_hi:[1,0,0]
  v_pk_fma_f32 v[146:147], v[114:115], s[60:61], -0.5 op_sel_hi:[1,0,0]
  v_pk_fma_f32 v[148:149], v[116:117], s[60:61], -0.5 op_sel_hi:[1,0,0]
  v_pk_fma_f32 v[150:151], v[118:119], s[60:61], -0.5 op_sel_hi:[1,0,0]
  v_pk_fma_f32 v[152:153], v[120:121], s[60:61], -0.5 op_sel_hi:[1,0,0]
  v_pk_fma_f32 v[154:155], v[122:123], s[60:61], -0.5 op_sel_hi:[1,0,0]
  v_pk_fma_f32 v[156:157], v[124:125], s[60:61], -0.5 op_sel_hi:[1,0,0]
  v_pk_fma_f32 v[158:159], v[126:127], s[60:61], -0.5 op_sel_hi:[1,0,0]
  v_exp_f32 v144, v144
  buffer_store_dwordx4 v[100:103], v28, s[28:31], s72 offen offset:0 sc1
  v_exp_f32 v145, v145
  v_exp_f32 v146, v146
  v_exp_f32 v147, v147
  v_exp_f32 v148, v148
  v_exp_f32 v149, v149
  v_exp_f32 v150, v150
  v_exp_f32 v151, v151
  v_exp_f32 v152, v152
  v_exp_f32 v153, v153
  v_exp_f32 v154, v154
  v_exp_f32 v155, v155
  v_exp_f32 v156, v156
  v_exp_f32 v157, v157
  v_exp_f32 v158, v158
  v_exp_f32 v159, v159
  v_pk_add_f32 v[144:145], v[144:145], s[60:61] op_sel:[0,1] op_sel_hi:[1,1]
  v_pk_add_f32 v[146:147], v[146:147], s[60:61] op_sel:[0,1] op_sel_hi:[1,1]
  v_pk_add_f32 v[148:149], v[148:149], s[60:61] op_sel:[0,1] op_sel_hi:[1,1]
  v_pk_add_f32 v[150:151], v[150:151], s[60:61] op_sel:[0,1] op_sel_hi:[1,1]
  v_pk_add_f32 v[152:153], v[152:153], s[60:61] op_sel:[0,1] op_sel_hi:[1,1]
  v_pk_add_f32 v[154:155], v[154:155], s[60:61] op_sel:[0,1] op_sel_hi:[1,1]
  v_pk_add_f32 v[156:157], v[156:157], s[60:61] op_sel:[0,1] op_sel_hi:[1,1]
  v_pk_add_f32 v[158:159], v[158:159], s[60:61] op_sel:[0,1] op_sel_hi:[1,1]
  v_pk_fma_f32 v[144:145], v[144:145], v[144:145], 0.5 op_sel_hi:[1,1,0]
  v_pk_fma_f32 v[146:147], v[146:147], v[146:147], 0.5 op_sel_hi:[1,1,0]
  v_pk_fma_f32 v[148:149], v[148:149], v[148:149], 0.5 op_sel_hi:[1,1,0]
  v_pk_fma_f32 v[150:151], v[150:151], v[150:151], 0.5 op_sel_hi:[1,1,0]
  v_pk_fma_f32 v[152:153], v[152:153], v[152:153], 0.5 op_sel_hi:[1,1,0]
  v_pk_fma_f32 v[154:155], v[154:155], v[154:155], 0.5 op_sel_hi:[1,1,0]
  v_pk_fma_f32 v[156:157], v[156:157], v[156:157], 0.5 op_sel_hi:[1,1,0]
  v_pk_fma_f32 v[158:159], v[158:159], v[158:159], 0.5 op_sel_hi:[1,1,0]
  v_rcp_f32 v144, v144
  v_rcp_f32 v145, v145
  v_rcp_f32 v146, v146
  v_rcp_f32 v147, v147
  v_rcp_f32 v148, v148
  v_rcp_f32 v149, v149
  v_rcp_f32 v150, v150
  v_rcp_f32 v151, v151
  v_rcp_f32 v152, v152
  v_rcp_f32 v153, v153
  v_rcp_f32 v154, v154
  v_rcp_f32 v155, v155
  v_rcp_f32 v156, v156
  v_rcp_f32 v157, v157
  v_rcp_f32 v158, v158
  v_rcp_f32 v159, v159
  v_pk_fma_f32 v[144:145], v[112:113], v[144:145], v[112:113] neg_lo:[1,0,0] neg_hi:[1,0,0]
  v_pk_fma_f32 v[146:147], v[114:115], v[146:147], v[114:115] neg_lo:[1,0,0] neg_hi:[1,0,0]
  v_pk_fma_f32 v[148:149], v[116:117], v[148:149], v[116:117] neg_lo:[1,0,0] neg_hi:[1,0,0]
  v_pk_fma_f32 v[150:151], v[118:119], v[150:151], v[118:119] neg_lo:[1,0,0] neg_hi:[1,0,0]
  v_pk_fma_f32 v[152:153], v[120:121], v[152:153], v[120:121] neg_lo:[1,0,0] neg_hi:[1,0,0]
  v_pk_fma_f32 v[154:155], v[122:123], v[154:155], v[122:123] neg_lo:[1,0,0] neg_hi:[1,0,0]
  v_pk_fma_f32 v[156:157], v[124:125], v[156:157], v[124:125] neg_lo:[1,0,0] neg_hi:[1,0,0]
  v_pk_fma_f32 v[158:159], v[126:127], v[158:159], v[126:127] neg_lo:[1,0,0] neg_hi:[1,0,0]
  v_cvt_pk_bf16_f32 v112, v144, v145
  v_cvt_pk_bf16_f32 v113, v146, v147
  v_cvt_pk_bf16_f32 v114, v152, v153
  v_cvt_pk_bf16_f32 v115, v154, v155
  buffer_store_dwordx4 v[112:115], v27, s[28:31], s73 offen offset:0 sc1
  v_cvt_pk_bf16_f32 v116, v148, v149
  v_cvt_pk_bf16_f32 v117, v150, v151
  v_cvt_pk_bf16_f32 v118, v156, v157
  v_cvt_pk_bf16_f32 v119, v158, v159
  s_waitcnt vmcnt(15)
  s_barrier
  buffer_store_dwordx4 v[116:119], v28, s[28:31], s73 offen offset:0 sc1
  ds_read_b128 v[224:227], v24 offset:32768
  ds_read_b128 v[228:231], v24 offset:33792
  ds_read_b128 v[232:235], v24 offset:34816
  ds_read_b128 v[236:239], v24 offset:35840
  s_waitcnt lgkmcnt(3)
  v_mfma_f32_16x16x32_bf16 v[160:163], a[0:3], v[224:227], v[208:211]
  ds_read_b128 v[240:243], v24 offset:36864
  v_mfma_f32_16x16x32_bf16 v[164:167], a[4:7], v[224:227], v[208:211]
  ds_read_b128 v[244:247], v24 offset:37888
  s_waitcnt lgkmcnt(4)
  v_mfma_f32_16x16x32_bf16 v[168:171], a[0:3], v[228:231], v[208:211]
  s_add_u32 s75, s46, 8
  v_readlane_b32 s79, v22, s75
  s_add_u32 m0, s65, 49152
  s_nop 3
  buffer_load_dwordx4 v32, s[20:23], s79 offen offset:0 lds
  v_mfma_f32_16x16x32_bf16 v[172:175], a[4:7], v[228:231], v[208:211]
  s_waitcnt lgkmcnt(3)
  v_mfma_f32_16x16x32_bf16 v[176:179], a[0:3], v[232:235], 0
  ds_read_b128 v[248:251], v24 offset:38912
  v_mfma_f32_16x16x32_bf16 v[180:183], a[4:7], v[232:235], 0
  ds_read_b128 v[252:255], v24 offset:39936
  s_waitcnt lgkmcnt(4)
  v_mfma_f32_16x16x32_bf16 v[184:187], a[0:3], v[236:239], 0
  buffer_load_dwordx4 v33, s[20:23], s79 offen offset:1024 lds
  v_mfma_f32_16x16x32_bf16 v[188:191], a[4:7], v[236:239], 0
  s_waitcnt lgkmcnt(3)
  v_mfma_f32_16x16x32_bf16 v[160:163], a[8:11], v[240:243], v[160:163]
  ds_read_b128 v[224:227], v24 offset:40960
  v_mfma_f32_16x16x32_bf16 v[164:167], a[12:15], v[240:243], v[164:167]
  ds_read_b128 v[228:231], v24 offset:41984
  s_waitcnt lgkmcnt(4)
  v_mfma_f32_16x16x32_bf16 v[168:171], a[8:11], v[244:247], v[168:171]
  buffer_load_dwordx4 v34, s[20:23], s79 offen offset:2048 lds
  v_mfma_f32_16x16x32_bf16 v[172:175], a[12:15], v[244:247], v[172:175]
  s_waitcnt lgkmcnt(3)
  v_mfma_f32_16x16x32_bf16 v[176:179], a[8:11], v[248:251], v[176:179]
  ds_read_b128 v[232:235], v24 offset:43008
  v_mfma_f32_16x16x32_bf16 v[180:183], a[12:15], v[248:251], v[180:183]
  ds_read_b128 v[236:239], v24 offset:44032
  s_waitcnt lgkmcnt(4)
  v_mfma_f32_16x16x32_bf16 v[184:187], a[8:11], v[252:255], v[184:187]
  buffer_load_dwordx4 v35, s[20:23], s79 offen offset:3072 lds
  v_mfma_f32_16x16x32_bf16 v[188:191], a[12:15], v[252:255], v[188:191]
  s_waitcnt lgkmcnt(3)
  v_mfma_f32_16x16x32_bf16 v[160:163], a[16:19], v[224:227], v[160:163]
  ds_read_b128 v[240:243], v24 offset:45056
  v_mfma_f32_16x16x32_bf16 v[164:167], a[20:23], v[224:227], v[164:167]
  ds_read_b128 v[244:247], v24 offset:46080
  s_waitcnt lgkmcnt(4)
  v_mfma_f32_16x16x32_bf16 v[168:171], a[16:19], v[228:231], v[168:171]
  v_mfma_f32_16x16x32_bf16 v[172:175], a[20:23], v[228:231], v[172:175]
  s_waitcnt lgkmcnt(3)
  v_mfma_f32_16x16x32_bf16 v[176:179], a[16:19], v[232:235], v[176:179]
  ds_read_b128 v[248:251], v24 offset:47104
  v_mfma_f32_16x16x32_bf16 v[180:183], a[20:23], v[232:235], v[180:183]
  ds_read_b128 v[252:255], v24 offset:48128
  s_waitcnt lgkmcnt(4)
  v_mfma_f32_16x16x32_bf16 v[184:187], a[16:19], v[236:239], v[184:187]
  v_mfma_f32_16x16x32_bf16 v[188:191], a[20:23], v[236:239], v[188:191]
  s_waitcnt lgkmcnt(3)
  v_mfma_f32_16x16x32_bf16 v[160:163], a[24:27], v[240:243], v[160:163]
  ds_read_b128 v[224:227], v24 offset:49152
  v_mfma_f32_16x16x32_bf16 v[164:167], a[28:31], v[240:243], v[164:167]
  ds_read_b128 v[228:231], v24 offset:50176
  s_waitcnt lgkmcnt(4)
  v_mfma_f32_16x16x32_bf16 v[168:171], a[24:27], v[244:247], v[168:171]
  v_mfma_f32_16x16x32_bf16 v[172:175], a[28:31], v[244:247], v[172:175]
  s_waitcnt lgkmcnt(3)
  v_mfma_f32_16x16x32_bf16 v[176:179], a[24:27], v[248:251], v[176:179]
  ds_read_b128 v[232:235], v24 offset:51200
  v_mfma_f32_16x16x32_bf16 v[180:183], a[28:31], v[248:251], v[180:183]
  ds_read_b128 v[236:239], v24 offset:52224
  s_waitcnt lgkmcnt(4)
  v_mfma_f32_16x16x32_bf16 v[184:187], a[24:27], v[252:255], v[184:187]
  v_mfma_f32_16x16x32_bf16 v[188:191], a[28:31], v[252:255], v[188:191]
  s_waitcnt lgkmcnt(3)
  v_mfma_f32_16x16x32_bf16 v[160:163], a[32:35], v[224:227], v[160:163]
  ds_read_b128 v[240:243], v24 offset:53248
  v_mfma_f32_16x16x32_bf16 v[164:167], a[36:39], v[224:227], v[164:167]
  ds_read_b128 v[244:247], v24 offset:54272
  s_waitcnt lgkmcnt(4)
  v_mfma_f32_16x16x32_bf16 v[168:171], a[32:35], v[228:231], v[168:171]
  v_mfma_f32_16x16x32_bf16 v[172:175], a[36:39], v[228:231], v[172:175]
  s_waitcnt lgkmcnt(3)
  v_mfma_f32_16x16x32_bf16 v[176:179], a[32:35], v[232:235], v[176:179]
  ds_read_b128 v[248:251], v24 offset:55296
  v_mfma_f32_16x16x32_bf16 v[180:183], a[36:39], v[232:235], v[180:183]
  ds_read_b128 v[252:255], v24 offset:56320
  s_waitcnt lgkmcnt(4)
  v_mfma_f32_16x16x32_bf16 v[184:187], a[32:35], v[236:239], v[184:187]
  v_mfma_f32_16x16x32_bf16 v[188:191], a[36:39], v[236:239], v[188:191]
  s_waitcnt lgkmcnt(3)
  v_mfma_f32_16x16x32_bf16 v[160:163], a[40:43], v[240:243], v[160:163]
  ds_read_b128 v[224:227], v24 offset:57344
  v_mfma_f32_16x16x32_bf16 v[164:167], a[44:47], v[240:243], v[164:167]
  ds_read_b128 v[228:231], v24 offset:58368
  s_waitcnt lgkmcnt(4)
  v_mfma_f32_16x16x32_bf16 v[168:171], a[40:43], v[244:247], v[168:171]
  v_mfma_f32_16x16x32_bf16 v[172:175], a[44:47], v[244:247], v[172:175]
  s_waitcnt lgkmcnt(3)
  v_mfma_f32_16x16x32_bf16 v[176:179], a[40:43], v[248:251], v[176:179]
  ds_read_b128 v[232:235], v24 offset:59392
  v_mfma_f32_16x16x32_bf16 v[180:183], a[44:47], v[248:251], v[180:183]
  ds_read_b128 v[236:239], v24 offset:60416
  s_waitcnt lgkmcnt(4)
  v_mfma_f32_16x16x32_bf16 v[184:187], a[40:43], v[252:255], v[184:187]
  v_mfma_f32_16x16x32_bf16 v[188:191], a[44:47], v[252:255], v[188:191]
  s_waitcnt lgkmcnt(3)
  v_mfma_f32_16x16x32_bf16 v[160:163], a[48:51], v[224:227], v[160:163]
  ds_read_b128 v[240:243], v24 offset:61440
  v_mfma_f32_16x16x32_bf16 v[164:167], a[52:55], v[224:227], v[164:167]
  ds_read_b128 v[244:247], v24 offset:62464
  s_waitcnt lgkmcnt(4)
  v_mfma_f32_16x16x32_bf16 v[168:171], a[48:51], v[228:231], v[168:171]
  v_mfma_f32_16x16x32_bf16 v[172:175], a[52:55], v[228:231], v[172:175]
  s_waitcnt lgkmcnt(3)
  v_mfma_f32_16x16x32_bf16 v[176:179], a[48:51], v[232:235], v[176:179]
  ds_read_b128 v[248:251], v24 offset:63488
  v_mfma_f32_16x16x32_bf16 v[180:183], a[52:55], v[232:235], v[180:183]
  ds_read_b128 v[252:255], v24 offset:64512
  s_waitcnt lgkmcnt(4)
  v_mfma_f32_16x16x32_bf16 v[184:187], a[48:51], v[236:239], v[184:187]
  v_mfma_f32_16x16x32_bf16 v[188:191], a[52:55], v[236:239], v[188:191]
  s_waitcnt lgkmcnt(3)
  v_mfma_f32_16x16x32_bf16 v[160:163], a[56:59], v[240:243], v[160:163]
  ds_read_b128 v[224:227], v25 offset:0
  v_mfma_f32_16x16x32_bf16 v[164:167], a[60:63], v[240:243], v[164:167]
  ds_read_b128 v[228:231], v25 offset:1024
  s_waitcnt lgkmcnt(4)
  v_mfma_f32_16x16x32_bf16 v[168:171], a[56:59], v[244:247], v[168:171]
  v_mfma_f32_16x16x32_bf16 v[172:175], a[60:63], v[244:247], v[172:175]
  s_waitcnt lgkmcnt(3)
  v_mfma_f32_16x16x32_bf16 v[176:179], a[56:59], v[248:251], v[176:179]
  ds_read_b128 v[232:235], v25 offset:2048
  v_mfma_f32_16x16x32_bf16 v[180:183], a[60:63], v[248:251], v[180:183]
  ds_read_b128 v[236:239], v25 offset:3072
  s_waitcnt lgkmcnt(4)
  v_mfma_f32_16x16x32_bf16 v[184:187], a[56:59], v[252:255], v[184:187]
  v_mfma_f32_16x16x32_bf16 v[188:191], a[60:63], v[252:255], v[188:191]
  s_waitcnt lgkmcnt(3)
  v_mfma_f32_16x16x32_bf16 v[160:163], a[64:67], v[224:227], v[160:163]
  ds_read_b128 v[240:243], v25 offset:4096
  v_mfma_f32_16x16x32_bf16 v[164:167], a[68:71], v[224:227], v[164:167]
  ds_read_b128 v[244:247], v25 offset:5120
  s_waitcnt lgkmcnt(4)
  v_mfma_f32_16x16x32_bf16 v[168:171], a[64:67], v[228:231], v[168:171]
  v_mfma_f32_16x16x32_bf16 v[172:175], a[68:71], v[228:231], v[172:175]
  s_waitcnt lgkmcnt(3)
  v_mfma_f32_16x16x32_bf16 v[176:179], a[64:67], v[232:235], v[176:179]
  ds_read_b128 v[248:251], v25 offset:6144
  v_mfma_f32_16x16x32_bf16 v[180:183], a[68:71], v[232:235], v[180:183]
  ds_read_b128 v[252:255], v25 offset:7168
  s_waitcnt lgkmcnt(4)
  v_mfma_f32_16x16x32_bf16 v[184:187], a[64:67], v[236:239], v[184:187]
  v_mfma_f32_16x16x32_bf16 v[188:191], a[68:71], v[236:239], v[188:191]
  s_waitcnt lgkmcnt(3)
  v_mfma_f32_16x16x32_bf16 v[160:163], a[72:75], v[240:243], v[160:163]
  ds_read_b128 v[224:227], v25 offset:8192
  v_mfma_f32_16x16x32_bf16 v[164:167], a[76:79], v[240:243], v[164:167]
  ds_read_b128 v[228:231], v25 offset:9216
  s_waitcnt lgkmcnt(4)
  v_mfma_f32_16x16x32_bf16 v[168:171], a[72:75], v[244:247], v[168:171]
  v_mfma_f32_16x16x32_bf16 v[172:175], a[76:79], v[244:247], v[172:175]
  s_waitcnt lgkmcnt(3)
  v_mfma_f32_16x16x32_bf16 v[176:179], a[72:75], v[248:251], v[176:179]
  ds_read_b128 v[232:235], v25 offset:10240
  v_mfma_f32_16x16x32_bf16 v[180:183], a[76:79], v[248:251], v[180:183]
  ds_read_b128 v[236:239], v25 offset:11264
  s_waitcnt lgkmcnt(4)
  v_mfma_f32_16x16x32_bf16 v[184:187], a[72:75], v[252:255], v[184:187]
  v_mfma_f32_16x16x32_bf16 v[188:191], a[76:79], v[252:255], v[188:191]
  s_waitcnt lgkmcnt(3)
  v_mfma_f32_16x16x32_bf16 v[160:163], a[80:83], v[224:227], v[160:163]
  ds_read_b128 v[240:243], v25 offset:12288
  v_mfma_f32_16x16x32_bf16 v[164:167], a[84:87], v[224:227], v[164:167]
  ds_read_b128 v[244:247], v25 offset:13312
  s_waitcnt lgkmcnt(4)
  v_mfma_f32_16x16x32_bf16 v[168:171], a[80:83], v[228:231], v[168:171]
  v_mfma_f32_16x16x32_bf16 v[172:175], a[84:87], v[228:231], v[172:175]
  s_waitcnt vmcnt(4)
  s_mov_b32 s80, 32768
  buffer_store_dwordx2 v[52:53], v29, s[28:31], s80 offen sc1
  s_waitcnt lgkmcnt(3)
  v_mfma_f32_16x16x32_bf16 v[176:179], a[80:83], v[232:235], v[176:179]
  ds_read_b128 v[248:251], v25 offset:14336
  v_mfma_f32_16x16x32_bf16 v[180:183], a[84:87], v[232:235], v[180:183]
  ds_read_b128 v[252:255], v25 offset:15360
  s_waitcnt lgkmcnt(4)
  v_mfma_f32_16x16x32_bf16 v[184:187], a[80:83], v[236:239], v[184:187]
  v_mfma_f32_16x16x32_bf16 v[188:191], a[84:87], v[236:239], v[188:191]
  s_waitcnt lgkmcnt(3)
  v_mfma_f32_16x16x32_bf16 v[160:163], a[88:91], v[240:243], v[160:163]
  ds_read_b128 v[224:227], v25 offset:16384
  v_mfma_f32_16x16x32_bf16 v[164:167], a[92:95], v[240:243], v[164:167]
  ds_read_b128 v[228:231], v25 offset:17408
  s_waitcnt lgkmcnt(4)
  v_mfma_f32_16x16x32_bf16 v[168:171], a[88:91], v[244:247], v[168:171]
  v_mfma_f32_16x16x32_bf16 v[172:175], a[92:95], v[244:247], v[172:175]
  s_waitcnt lgkmcnt(3)
  v_mfma_f32_16x16x32_bf16 v[176:179], a[88:91], v[248:251], v[176:179]
  ds_read_b128 v[232:235], v25 offset:18432
  v_mfma_f32_16x16x32_bf16 v[180:183], a[92:95], v[248:251], v[180:183]
  ds_read_b128 v[236:239], v25 offset:19456
  s_waitcnt lgkmcnt(4)
  v_mfma_f32_16x16x32_bf16 v[184:187], a[88:91], v[252:255], v[184:187]
  v_mfma_f32_16x16x32_bf16 v[188:191], a[92:95], v[252:255], v[188:191]
  s_waitcnt lgkmcnt(3)
  v_mfma_f32_16x16x32_bf16 v[160:163], a[96:99], v[224:227], v[160:163]
  ds_read_b128 v[240:243], v25 offset:20480
  v_mfma_f32_16x16x32_bf16 v[164:167], a[100:103], v[224:227], v[164:167]
  ds_read_b128 v[244:247], v25 offset:21504
  s_waitcnt lgkmcnt(4)
  v_mfma_f32_16x16x32_bf16 v[168:171], a[96:99], v[228:231], v[168:171]
  v_mfma_f32_16x16x32_bf16 v[172:175], a[100:103], v[228:231], v[172:175]
  s_waitcnt lgkmcnt(3)
  v_mfma_f32_16x16x32_bf16 v[176:179], a[96:99], v[232:235], v[176:179]
  ds_read_b128 v[248:251], v25 offset:22528
  v_mfma_f32_16x16x32_bf16 v[180:183], a[100:103], v[232:235], v[180:183]
  ds_read_b128 v[252:255], v25 offset:23552
  s_waitcnt lgkmcnt(4)
  v_mfma_f32_16x16x32_bf16 v[184:187], a[96:99], v[236:239], v[184:187]
  v_mfma_f32_16x16x32_bf16 v[188:191], a[100:103], v[236:239], v[188:191]
  s_waitcnt lgkmcnt(3)
  v_mfma_f32_16x16x32_bf16 v[160:163], a[104:107], v[240:243], v[160:163]
  v_mfma_f32_16x16x32_bf16 v[164:167], a[108:111], v[240:243], v[164:167]
  s_waitcnt lgkmcnt(2)
  v_mfma_f32_16x16x32_bf16 v[168:171], a[104:107], v[244:247], v[168:171]
  v_mfma_f32_16x16x32_bf16 v[172:175], a[108:111], v[244:247], v[172:175]
  s_waitcnt lgkmcnt(1)
  v_mfma_f32_16x16x32_bf16 v[176:179], a[104:107], v[248:251], v[176:179]
  v_mfma_f32_16x16x32_bf16 v[180:183], a[108:111], v[248:251], v[180:183]
  s_waitcnt lgkmcnt(0)
  v_mfma_f32_16x16x32_bf16 v[184:187], a[104:107], v[252:255], v[184:187]
  v_mfma_f32_16x16x32_bf16 v[188:191], a[108:111], v[252:255], v[188:191]
  ds_read_b128 v[224:227], v23 offset:16384
  ds_read_b128 v[228:231], v23 offset:17408
  ds_read_b128 v[232:235], v23 offset:18432
  ds_read_b128 v[236:239], v23 offset:19456
  s_waitcnt lgkmcnt(3)
  v_mfma_f32_16x16x32_bf16 v[192:195], v[224:227], a[0:3], v[208:211]
  ds_read_b128 v[240:243], v23 offset:20480
  v_mfma_f32_16x16x32_bf16 v[196:199], v[224:227], a[4:7], v[208:211]
  ds_read_b128 v[244:247], v23 offset:21504
  s_waitcnt lgkmcnt(4)
  v_mfma_f32_16x16x32_bf16 v[200:203], v[228:231], a[0:3], v[208:211]
  v_mov_b32 v20, s63
  v_fma_f32 v2, v160, s62, v20
  v_fma_f32 v3, v161, s62, v20
  v_fma_f32 v4, v162, s62, v20
  v_fma_f32 v5, v163, s62, v20
  v_mfma_f32_16x16x32_bf16 v[204:207], v[228:231], a[4:7], v[208:211]
  v_fma_f32 v6, v164, s62, v20
  v_fma_f32 v7, v165, s62, v20
  v_fma_f32 v8, v166, s62, v20
  v_fma_f32 v9, v167, s62, v20
  s_waitcnt lgkmcnt(3)
  v_mfma_f32_16x16x32_bf16 v[192:195], v[232:235], a[8:11], v[192:195]
  v_fma_f32 v10, v168, s62, v20
  v_fma_f32 v11, v169, s62, v20
  v_fma_f32 v12, v170, s62, v20
  v_fma_f32 v13, v171, s62, v20
  ds_read_b128 v[248:251], v23 offset:22528
  v_mfma_f32_16x16x32_bf16 v[196:199], v[232:235], a[12:15], v[196:199]
  v_fma_f32 v14, v172, s62, v20
  v_fma_f32 v15, v173, s62, v20
  v_fma_f32 v16, v174, s62, v20
  v_fma_f32 v17, v175, s62, v20
  ds_read_b128 v[252:255], v23 offset:23552
  s_waitcnt lgkmcnt(4)
  v_mfma_f32_16x16x32_bf16 v[200:203], v[236:239], a[8:11], v[200:203]
  v_exp_f32_e64 v2, v2 clamp
  v_exp_f32_e64 v3, v3 clamp
  v_exp_f32_e64 v4, v4 clamp
  v_exp_f32_e64 v5, v5 clamp
  v_mfma_f32_16x16x32_bf16 v[204:207], v[236:239], a[12:15], v[204:207]
  v_exp_f32_e64 v6, v6 clamp
  v_exp_f32_e64 v7, v7 clamp
  v_exp_f32_e64 v8, v8 clamp
  v_exp_f32_e64 v9, v9 clamp
  s_waitcnt lgkmcnt(3)
  v_mfma_f32_16x16x32_bf16 v[192:195], v[240:243], a[16:19], v[192:195]
  v_exp_f32_e64 v10, v10 clamp
  v_exp_f32_e64 v11, v11 clamp
  v_exp_f32_e64 v12, v12 clamp
  v_exp_f32_e64 v13, v13 clamp
  ds_read_b128 v[224:227], v23 offset:24576
  v_mfma_f32_16x16x32_bf16 v[196:199], v[240:243], a[20:23], v[196:199]
  v_exp_f32_e64 v14, v14 clamp
  v_exp_f32_e64 v15, v15 clamp
  v_exp_f32_e64 v16, v16 clamp
  v_exp_f32_e64 v17, v17 clamp
  ds_read_b128 v[228:231], v23 offset:25600
  s_waitcnt lgkmcnt(4)
  v_mfma_f32_16x16x32_bf16 v[200:203], v[244:247], a[16:19], v[200:203]
  v_max_f32 v160, s64, v160
  v_max_f32 v161, s64, v161
  v_max_f32 v162, s64, v162
  v_max_f32 v163, s64, v163
  v_mfma_f32_16x16x32_bf16 v[204:207], v[244:247], a[20:23], v[204:207]
  v_max_f32 v164, s64, v164
  v_max_f32 v165, s64, v165
  v_max_f32 v166, s64, v166
  v_max_f32 v167, s64, v167
  s_waitcnt lgkmcnt(3)
  v_mfma_f32_16x16x32_bf16 v[192:195], v[248:251], a[24:27], v[192:195]
  v_max_f32 v168, s64, v168
  v_max_f32 v169, s64, v169
  v_max_f32 v170, s64, v170
  v_max_f32 v171, s64, v171
  ds_read_b128 v[232:235], v23 offset:26624
  v_mfma_f32_16x16x32_bf16 v[196:199], v[248:251], a[28:31], v[196:199]
  v_max_f32 v172, s64, v172
  v_max_f32 v173, s64, v173
  v_max_f32 v174, s64, v174
  v_max_f32 v175, s64, v175
  v_add_f32 v160, v160, v2
  ds_read_b128 v[236:239], v23 offset:27648
  s_waitcnt lgkmcnt(4)
  v_mfma_f32_16x16x32_bf16 v[200:203], v[252:255], a[24:27], v[200:203]
  v_add_f32 v161, v161, v3
  v_add_f32 v162, v162, v4
  v_add_f32 v163, v163, v5
  v_add_f32 v164, v164, v6
  v_mfma_f32_16x16x32_bf16 v[204:207], v[252:255], a[28:31], v[204:207]
  buffer_load_dwordx2 v[222:223], v31, s[28:31], 0 offen sc1
  v_add_f32 v165, v165, v7
  v_add_f32 v166, v166, v8
  v_add_f32 v167, v167, v9
  v_add_f32 v168, v168, v10
  s_waitcnt lgkmcnt(3)
  v_mfma_f32_16x16x32_bf16 v[192:195], v[224:227], a[32:35], v[192:195]
  v_add_f32 v169, v169, v11
  v_add_f32 v170, v170, v12
  v_add_f32 v171, v171, v13
  v_add_f32 v172, v172, v14
  ds_read_b128 v[240:243], v23 offset:28672
  v_mfma_f32_16x16x32_bf16 v[196:199], v[224:227], a[36:39], v[196:199]
  v_add_f32 v173, v173, v15
  v_add_f32 v174, v174, v16
  v_add_f32 v175, v175, v17
  v_cvt_pk_bf16_f32 v176, v176, v177
  ds_read_b128 v[244:247], v23 offset:29696
  s_waitcnt lgkmcnt(4)
  v_mfma_f32_16x16x32_bf16 v[200:203], v[228:231], a[32:35], v[200:203]
  v_cvt_pk_bf16_f32 v177, v178, v179
  v_cvt_pk_bf16_f32 v178, v180, v181
  v_cvt_pk_bf16_f32 v179, v182, v183
  v_cvt_pk_bf16_f32 v184, v184, v185
  v_mfma_f32_16x16x32_bf16 v[204:207], v[228:231], a[36:39], v[204:207]
  v_cvt_pk_bf16_f32 v185, v186, v187
  v_cvt_pk_bf16_f32 v186, v188, v189
  v_cvt_pk_bf16_f32 v187, v190, v191
  v_mov_b32 v54, 0x3f803f80
  s_waitcnt lgkmcnt(3)
  v_mfma_f32_16x16x32_bf16 v[192:195], v[232:235], a[40:43], v[192:195]
  v_cvt_pk_bf16_f32 v160, v160, v161
  v_cvt_pk_bf16_f32 v161, v162, v163
  v_cvt_pk_bf16_f32 v162, v164, v165
  v_cvt_pk_bf16_f32 v163, v166, v167
  ds_read_b128 v[248:251], v23 offset:30720
  v_mfma_f32_16x16x32_bf16 v[196:199], v[232:235], a[44:47], v[196:199]
  v_cvt_pk_bf16_f32 v168, v168, v169
  v_cvt_pk_bf16_f32 v169, v170, v171
  v_cvt_pk_bf16_f32 v170, v172, v173
  v_cvt_pk_bf16_f32 v171, v174, v175
  ds_read_b128 v[252:255], v23 offset:31744
  s_waitcnt lgkmcnt(4)
  v_mfma_f32_16x16x32_bf16 v[200:203], v[236:239], a[40:43], v[200:203]
  v_cndmask_b32_e64 v184, v184, v54, s[66:67]
  v_cndmask_b32_e64 v185, v185, v54, s[66:67]
  v_cndmask_b32_e64 v186, v186, v54, s[66:67]
  v_cndmask_b32_e64 v187, v187, v54, s[66:67]
  v_mfma_f32_16x16x32_bf16 v[204:207], v[236:239], a[44:47], v[204:207]
  v_mfma_f32_16x16x32_bf16 v[164:167], v[160:163], v[176:179], 0
  v_mfma_f32_16x16x32_bf16 v[172:175], v[160:163], v[184:187], 0
  v_mfma_f32_16x16x32_bf16 v[180:183], v[168:171], v[176:179], 0
  v_mfma_f32_16x16x32_bf16 v[188:191], v[168:171], v[184:187], 0
  s_waitcnt lgkmcnt(3)
  v_mfma_f32_16x16x32_bf16 v[192:195], v[240:243], a[48:51], v[192:195]
  ds_read_b128 v[224:227], v23 offset:32768
  v_mfma_f32_16x16x32_bf16 v[196:199], v[240:243], a[52:55], v[196:199]
  ds_read_b128 v[228:231], v23 offset:33792
  s_waitcnt lgkmcnt(4)
  v_mfma_f32_16x16x32_bf16 v[200:203], v[244:247], a[48:51], v[200:203]
  v_mfma_f32_16x16x32_bf16 v[204:207], v[244:247], a[52:55], v[204:207]
  ds_write_b128 v57, v[164:167] offset:0
  ds_write_b128 v57, v[172:175] offset:4096
  ds_write_b128 v57, v[180:183] offset:8192
  ds_write_b128 v57, v[188:191] offset:12288
  s_waitcnt lgkmcnt(0)
  s_barrier
  s_add_u32 s75, s46, 12
  v_readlane_b32 s79, v22, s75
  s_add_u32 m0, s65, 98304
  s_nop 3
  buffer_load_dwordx4 v32, s[20:23], s79 offen offset:0 lds
  ds_read_b128 v[128:131], v58 offset:0
  ds_read_b128 v[132:135], v58 offset:1024
  ds_read_b128 v[136:139], v58 offset:2048
  ds_read_b128 v[140:143], v58 offset:3072
  ds_read_b128 v[144:147], v58 offset:8192
  ds_read_b128 v[148:151], v58 offset:9216
  ds_read_b128 v[152:155], v58 offset:10240
  ds_read_b128 v[156:159], v58 offset:11264
  v_mfma_f32_16x16x32_bf16 v[192:195], v[248:251], a[56:59], v[192:195]
  ds_read_b128 v[232:235], v23 offset:34816
  v_mfma_f32_16x16x32_bf16 v[196:199], v[248:251], a[60:63], v[196:199]
  buffer_load_dwordx4 v33, s[20:23], s79 offen offset:1024 lds
  ds_read_b128 v[236:239], v23 offset:36864
  v_mfma_f32_16x16x32_bf16 v[200:203], v[252:255], a[56:59], v[200:203]
  v_mfma_f32_16x16x32_bf16 v[204:207], v[252:255], a[60:63], v[204:207]
  v_mfma_f32_16x16x32_bf16 v[192:195], v[224:227], a[64:67], v[192:195]
  ds_read_b128 v[240:243], v23 offset:37888
  v_mfma_f32_16x16x32_bf16 v[196:199], v[224:227], a[68:71], v[196:199]
  buffer_load_dwordx4 v34, s[20:23], s79 offen offset:2048 lds
  ds_read_b128 v[244:247], v23 offset:38912
  v_mfma_f32_16x16x32_bf16 v[200:203], v[228:231], a[64:67], v[200:203]
  v_mfma_f32_16x16x32_bf16 v[204:207], v[228:231], a[68:71], v[204:207]
  s_waitcnt lgkmcnt(10)
  v_add_f32 v128, v128, v132
  v_add_f32 v129, v129, v133
  v_add_f32 v130, v130, v134
  v_add_f32 v131, v131, v135
  s_waitcnt lgkmcnt(8)
  v_add_f32 v136, v136, v140
  v_add_f32 v137, v137, v141
  v_add_f32 v138, v138, v142
  buffer_load_dwordx4 v35, s[20:23], s79 offen offset:3072 lds
  v_add_f32 v139, v139, v143
  v_add_f32 v128, v128, v136
  v_add_f32 v129, v129, v137
  v_add_f32 v130, v130, v138
  v_add_f32 v131, v131, v139
  s_waitcnt lgkmcnt(6)
  v_add_f32 v144, v144, v148
  v_add_f32 v145, v145, v149
  v_add_f32 v146, v146, v150
  v_add_f32 v147, v147, v151
  s_waitcnt lgkmcnt(4)
  v_add_f32 v152, v152, v156
  v_add_f32 v153, v153, v157
  v_add_f32 v154, v154, v158
  v_add_f32 v155, v155, v159
  v_add_f32 v144, v144, v152
  v_add_f32 v145, v145, v153
  s_add_u32 s75, s46, 16
  v_readlane_b32 s79, v22, s75
  s_add_u32 m0, s65, 114688
  s_nop 3
  buffer_load_dwordx4 v32, s[20:23], s79 offen offset:0 lds
  v_add_f32 v146, v146, v154
  v_add_f32 v147, v147, v155
  v_cvt_pk_bf16_f32 v128, v128, v129
  v_cvt_pk_bf16_f32 v129, v130, v131
  v_cvt_pk_bf16_f32 v130, v144, v145
  v_cvt_pk_bf16_f32 v131, v146, v147
  v_and_or_b32 v131, v131, s68, v213
  buffer_store_dwordx4 v[128:131], v55, s[28:31], 0 offen offset:0 sc1
  s_waitcnt lgkmcnt(3)
  v_mfma_f32_16x16x32_bf16 v[192:195], v[232:235], a[72:75], v[192:195]
  ds_read_b128 v[248:251], v23 offset:40960
  v_mfma_f32_16x16x32_bf16 v[196:199], v[232:235], a[76:79], v[196:199]
  ds_read_b128 v[252:255], v23 offset:41984
  s_waitcnt lgkmcnt(4)
  v_mfma_f32_16x16x32_bf16 v[200:203], v[236:239], a[72:75], v[200:203]
  v_mfma_f32_16x16x32_bf16 v[204:207], v[236:239], a[76:79], v[204:207]
  s_waitcnt lgkmcnt(3)
  v_mfma_f32_16x16x32_bf16 v[192:195], v[240:243], a[80:83], v[192:195]
  ds_read_b128 v[224:227], v23 offset:43008
  v_mfma_f32_16x16x32_bf16 v[196:199], v[240:243], a[84:87], v[196:199]
  buffer_load_dwordx4 v33, s[20:23], s79 offen offset:1024 lds
  ds_read_b128 v[228:231], v23 offset:45056
  s_waitcnt lgkmcnt(4)
  v_mfma_f32_16x16x32_bf16 v[200:203], v[244:247], a[80:83], v[200:203]
  v_mfma_f32_16x16x32_bf16 v[204:207], v[244:247], a[84:87], v[204:207]
  s_waitcnt lgkmcnt(3)
  v_mfma_f32_16x16x32_bf16 v[192:195], v[248:251], a[88:91], v[192:195]
  ds_read_b128 v[232:235], v23 offset:46080
  v_mfma_f32_16x16x32_bf16 v[196:199], v[248:251], a[92:95], v[196:199]
  buffer_load_dwordx4 v34, s[20:23], s79 offen offset:2048 lds
  ds_read_b128 v[236:239], v23 offset:47104
  s_waitcnt lgkmcnt(4)
  v_mfma_f32_16x16x32_bf16 v[200:203], v[252:255], a[88:91], v[200:203]
  v_mfma_f32_16x16x32_bf16 v[204:207], v[252:255], a[92:95], v[204:207]
  s_waitcnt lgkmcnt(3)
  v_mfma_f32_16x16x32_bf16 v[192:195], v[224:227], a[96:99], v[192:195]
  v_mfma_f32_16x16x32_bf16 v[196:199], v[224:227], a[100:103], v[196:199]
  buffer_load_dwordx4 v35, s[20:23], s79 offen offset:3072 lds
  s_waitcnt lgkmcnt(2)
  v_mfma_f32_16x16x32_bf16 v[200:203], v[228:231], a[96:99], v[200:203]
  v_mfma_f32_16x16x32_bf16 v[204:207], v[228:231], a[100:103], v[204:207]
  s_waitcnt lgkmcnt(1)
  v_mfma_f32_16x16x32_bf16 v[192:195], v[232:235], a[104:107], v[192:195]
  v_mfma_f32_16x16x32_bf16 v[196:199], v[232:235], a[108:111], v[196:199]
  s_add_u32 s75, s46, 20
  v_readlane_b32 s79, v22, s75
  s_add_u32 m0, s65, 131072
  s_nop 3
  buffer_load_dwordx4 v32, s[20:23], s79 offen offset:0 lds
  s_waitcnt lgkmcnt(0)
  v_mfma_f32_16x16x32_bf16 v[200:203], v[236:239], a[104:107], v[200:203]
  v_mfma_f32_16x16x32_bf16 v[204:207], v[236:239], a[108:111], v[204:207]
  s_waitcnt vmcnt(12)
  s_barrier
  buffer_load_dwordx4 v33, s[20:23], s79 offen offset:1024 lds
  buffer_load_dwordx4 v34, s[20:23], s79 offen offset:2048 lds
  buffer_load_dwordx4 v35, s[20:23], s79 offen offset:3072 lds
  s_cmp_eq_u32 s52, 7
  s_cbranch_scc1 L_idle
  ds_read_b64_tr_b16 v[224:225], v44 offset:0
  ds_read_b64_tr_b16 v[226:227], v44 offset:1024
  ds_read_b64_tr_b16 v[228:229], v45 offset:0
  ds_read_b64_tr_b16 v[230:231], v45 offset:1024
  ds_read_b64_tr_b16 v[232:233], v46 offset:0
  ds_read_b64_tr_b16 v[234:235], v46 offset:1024
  ds_read_b64_tr_b16 v[236:237], v47 offset:0
  ds_read_b64_tr_b16 v[238:239], v47 offset:1024
  s_waitcnt lgkmcnt(6)
  v_mfma_f32_16x16x32_bf16 v[72:75], v[224:227], v[64:67], 0
  ds_read_b64_tr_b16 v[240:241], v44 offset:4096
  v_fma_f32 v2, v192, s62, v20
  v_mfma_f32_16x16x32_bf16 v[76:79], v[224:227], v[68:71], 0
  ds_read_b64_tr_b16 v[242:243], v44 offset:5120
  v_fma_f32 v3, v193, s62, v20
  s_waitcnt lgkmcnt(6)
  v_mfma_f32_16x16x32_bf16 v[88:91], v[228:231], v[64:67], 0
  ds_read_b64_tr_b16 v[244:245], v45 offset:4096
  v_fma_f32 v4, v194, s62, v20
  v_mfma_f32_16x16x32_bf16 v[92:95], v[228:231], v[68:71], 0
  ds_read_b64_tr_b16 v[246:247], v45 offset:5120
  v_fma_f32 v5, v195, s62, v20
  s_waitcnt lgkmcnt(6)
  v_mfma_f32_16x16x32_bf16 v[104:107], v[232:235], v[64:67], 0
  ds_read_b64_tr_b16 v[248:249], v46 offset:4096
  v_fma_f32 v6, v196, s62, v20
  v_mfma_f32_16x16x32_bf16 v[108:111], v[232:235], v[68:71], 0
  s_add_u32 m0, s65, 16384
  s_add_u32 s78, s81, 0
  buffer_load_dwordx4 v32, s[24:27], s78 offen offset:0 lds
  ds_read_b64_tr_b16 v[250:251], v46 offset:5120
  s_waitcnt lgkmcnt(6)
  v_mfma_f32_16x16x32_bf16 v[120:123], v[236:239], v[64:67], 0
  ds_read_b64_tr_b16 v[252:253], v47 offset:4096
  v_fma_f32 v7, v197, s62, v20
  v_mfma_f32_16x16x32_bf16 v[124:127], v[236:239], v[68:71], 0
  ds_read_b64_tr_b16 v[254:255], v47 offset:5120
  v_fma_f32 v8, v198, s62, v20
  s_waitcnt lgkmcnt(6)
  v_mfma_f32_16x16x32_bf16 v[72:75], v[240:243], v[80:83], v[72:75]
  ds_read_b64_tr_b16 v[224:225], v44 offset:8192
  v_fma_f32 v9, v199, s62, v20
  buffer_load_dwordx4 v36, s[24:27], s78 offen offset:1024 lds
  v_mfma_f32_16x16x32_bf16 v[76:79], v[240:243], v[84:87], v[76:79]
  ds_read_b64_tr_b16 v[226:227], v44 offset:9216
  v_fma_f32 v10, v200, s62, v20
  s_waitcnt lgkmcnt(6)
  v_mfma_f32_16x16x32_bf16 v[88:91], v[244:247], v[80:83], v[88:91]
  ds_read_b64_tr_b16 v[228:229], v45 offset:8192
  v_fma_f32 v11, v201, s62, v20
  v_mfma_f32_16x16x32_bf16 v[92:95], v[244:247], v[84:87], v[92:95]
  ds_read_b64_tr_b16 v[230:231], v45 offset:9216
  v_fma_f32 v12, v202, s62, v20
  s_waitcnt lgkmcnt(6)
  v_mfma_f32_16x16x32_bf16 v[104:107], v[248:251], v[80:83], v[104:107]
  s_waitcnt vmcnt(15)
L_chk8:
  v_cmp_ne_u64 vcc, v[222:223], v[52:53]
  s_cmp_lg_u64 vcc, 0
  s_cbranch_scc1 L_spin8
L_ok8:
  buffer_load_dwordx4 v34, s[24:27], s78 offen offset:2048 lds
  ds_read_b64_tr_b16 v[232:233], v46 offset:8192
  v_mfma_f32_16x16x32_bf16 v[108:111], v[248:251], v[84:87], v[108:111]
  ds_read_b64_tr_b16 v[234:235], v46 offset:9216
  v_fma_f32 v13, v203, s62, v20
  s_waitcnt lgkmcnt(6)
  v_mfma_f32_16x16x32_bf16 v[120:123], v[252:255], v[80:83], v[120:123]
  ds_read_b64_tr_b16 v[236:237], v47 offset:8192
  v_fma_f32 v14, v204, s62, v20
  v_mfma_f32_16x16x32_bf16 v[124:127], v[252:255], v[84:87], v[124:127]
  ds_read_b64_tr_b16 v[238:239], v47 offset:9216
  v_fma_f32 v15, v205, s62, v20
  buffer_load_dwordx4 v37, s[24:27], s78 offen offset:3072 lds
  s_waitcnt lgkmcnt(6)
  v_mfma_f32_16x16x32_bf16 v[72:75], v[224:227], v[96:99], v[72:75]
  ds_read_b64_tr_b16 v[240:241], v44 offset:12288
  v_fma_f32 v16, v206, s62, v20
  v_mfma_f32_16x16x32_bf16 v[76:79], v[224:227], v[100:103], v[76:79]
  ds_read_b64_tr_b16 v[242:243], v44 offset:13312
  v_fma_f32 v17, v207, s62, v20
  s_waitcnt lgkmcnt(6)
  v_mfma_f32_16x16x32_bf16 v[88:91], v[228:231], v[96:99], v[88:91]
  ds_read_b64_tr_b16 v[244:245], v45 offset:12288
  v_exp_f32_e64 v62, -v13
  v_mfma_f32_16x16x32_bf16 v[92:95], v[228:231], v[100:103], v[92:95]
  buffer_load_dwordx4 a[176:179], v27, s[28:31], s77 offen sc1
  ds_read_b64_tr_b16 v[246:247], v45 offset:13312
  s_waitcnt lgkmcnt(6)
  v_mfma_f32_16x16x32_bf16 v[104:107], v[232:235], v[96:99], v[104:107]
  ds_read_b64_tr_b16 v[248:249], v46 offset:12288
  v_exp_f32_e64 v63, -v17
  v_mfma_f32_16x16x32_bf16 v[108:111], v[232:235], v[100:103], v[108:111]
  ds_read_b64_tr_b16 v[250:251], v46 offset:13312
  v_exp_f32_e64 v2, v2 clamp
  s_waitcnt lgkmcnt(6)
  v_mfma_f32_16x16x32_bf16 v[120:123], v[236:239], v[96:99], v[120:123]
  ds_read_b64_tr_b16 v[252:253], v47 offset:12288
  v_exp_f32_e64 v3, v3 clamp
  buffer_load_dwordx4 a[180:183], v28, s[28:31], s77 offen sc1
  v_readlane_b32 s77, v212, 5
  v_mfma_f32_16x16x32_bf16 v[124:127], v[236:239], v[100:103], v[124:127]
  ds_read_b64_tr_b16 v[254:255], v47 offset:13312
  v_exp_f32_e64 v4, v4 clamp
  v_exp_f32_e64 v5, v5 clamp
  v_add_f32 v62, 1.0, v62
  v_add_f32 v63, 1.0, v63
  v_exp_f32_e64 v6, v6 clamp
  v_exp_f32_e64 v7, v7 clamp
  buffer_load_dwordx4 v[128:131], v56, s[28:31], 0 offen offset:0 sc1
  v_exp_f32_e64 v8, v8 clamp
  v_exp_f32_e64 v9, v9 clamp
  v_rcp_f32 v62, v62
  v_rcp_f32 v63, v63
  v_exp_f32_e64 v10, v10 clamp
  v_exp_f32_e64 v11, v11 clamp
  v_exp_f32_e64 v12, v12 clamp
  v_exp_f32_e64 v13, v13 clamp
  v_exp_f32_e64 v14, v14 clamp
  v_exp_f32_e64 v15, v15 clamp
  v_exp_f32_e64 v16, v16 clamp
  v_exp_f32_e64 v17, v17 clamp
  v_max_f32 v192, s64, v192
  v_max_f32 v193, s64, v193
  buffer_load_dwordx4 v[132:135], v56, s[28:31], 0 offen offset:1024 sc1
  v_max_f32 v194, s64, v194
  v_max_f32 v195, s64, v195
  v_max_f32 v196, s64, v196
  v_max_f32 v197, s64, v197
  v_max_f32 v198, s64, v198
  v_max_f32 v199, s64, v199
  v_max_f32 v200, s64, v200
  v_max_f32 v201, s64, v201
  v_max_f32 v202, s64, v202
  v_max_f32 v203, s64, v203
  v_max_f32 v204, s64, v204
  v_max_f32 v205, s64, v205
  v_max_f32 v206, s64, v206
  v_max_f32 v207, s64, v207
  v_add_f32 v192, v192, v2
  v_add_f32 v193, v193, v3
  v_add_f32 v194, v194, v4
  buffer_load_dwordx4 v[136:139], v56, s[28:31], 0 offen offset:2048 sc1
  v_add_f32 v195, v195, v5
  v_add_f32 v196, v196, v6
  v_add_f32 v197, v197, v7
  v_add_f32 v198, v198, v8
  v_add_f32 v199, v199, v9
  v_add_f32 v200, v200, v10
  v_add_f32 v201, v201, v11
  v_add_f32 v202, v202, v12
  v_add_f32 v203, v203, v13
  v_add_f32 v204, v204, v14
  v_add_f32 v205, v205, v15
  v_add_f32 v206, v206, v16
  v_add_f32 v207, v207, v17
  v_cvt_pk_bf16_f32 v192, v192, v193
  v_cvt_pk_bf16_f32 v193, v194, v195
  v_cvt_pk_bf16_f32 v194, v200, v201
  buffer_load_dwordx4 v[140:143], v56, s[28:31], 0 offen offset:3072 sc1
  v_cvt_pk_bf16_f32 v195, v202, v203
  v_cvt_pk_bf16_f32 v196, v196, v197
  v_cvt_pk_bf16_f32 v197, v198, v199
  v_cvt_pk_bf16_f32 v198, v204, v205
  v_cvt_pk_bf16_f32 v199, v206, v207
  v_and_b32 v195, 0xffff, v195
  v_and_b32 v199, 0xffff, v199
  v_sub_f32 v210, 1.0, v62
  s_movk_i32 s78, 4096
  buffer_load_dwordx4 v[144:147], v56, s[28:31], s78 offen offset:0 sc1
  buffer_load_dwordx4 v[148:151], v56, s[28:31], s78 offen offset:1024 sc1
  buffer_load_dwordx4 v[152:155], v56, s[28:31], s78 offen offset:2048 sc1
  buffer_load_dwordx4 v[156:159], v56, s[28:31], s78 offen offset:3072 sc1
  buffer_load_dwordx4 a[184:187], v27, s[28:31], s76 offen sc1
  buffer_load_dwordx4 a[188:191], v28, s[28:31], s76 offen sc1
  v_readlane_b32 s76, v212, 6
  buffer_load_dwordx4 a[192:195], v27, s[28:31], s77 offen sc1
  buffer_load_dwordx4 a[196:199], v28, s[28:31], s77 offen sc1
  v_readlane_b32 s77, v212, 7
  s_nop 1
  buffer_load_dwordx4 a[200:203], v27, s[28:31], s76 offen sc1
  buffer_load_dwordx4 a[204:207], v28, s[28:31], s76 offen sc1
  v_readlane_b32 s76, v212, 8
  buffer_load_dwordx4 a[208:211], v27, s[28:31], s77 offen sc1
  buffer_load_dwordx4 a[212:215], v28, s[28:31], s77 offen sc1
  v_readlane_b32 s77, v212, 9
  s_nop 1
  buffer_load_dwordx4 a[216:219], v27, s[28:31], s76 offen sc1
  buffer_load_dwordx4 a[220:223], v28, s[28:31], s76 offen sc1
  v_readlane_b32 s76, v212, 10
  buffer_load_dwordx4 a[224:227], v27, s[28:31], s77 offen sc1
  s_waitcnt vmcnt(19)
  buffer_load_dwordx4 a[228:231], v28, s[28:31], s77 offen sc1
  v_readlane_b32 s77, v212, 11
  s_waitcnt lgkmcnt(6)
  v_mfma_f32_16x16x32_bf16 v[72:75], v[240:243], a[176:179], v[72:75]
  ds_read_b64_tr_b16 v[224:225], v44 offset:16384
  v_mfma_f32_16x16x32_bf16 v[76:79], v[240:243], a[180:183], v[76:79]
  ds_read_b64_tr_b16 v[226:227], v44 offset:17408
  s_waitcnt lgkmcnt(6)
  v_mfma_f32_16x16x32_bf16 v[88:91], v[244:247], a[176:179], v[88:91]
  ds_read_b64_tr_b16 v[228:229], v45 offset:16384
  v_mfma_f32_16x16x32_bf16 v[92:95], v[244:247], a[180:183], v[92:95]
  buffer_load_dwordx4 a[232:235], v27, s[28:31], s76 offen sc1
  ds_read_b64_tr_b16 v[230:231], v45 offset:17408
  s_waitcnt lgkmcnt(6)
  v_mfma_f32_16x16x32_bf16 v[104:107], v[248:251], a[176:179], v[104:107]
  ds_read_b64_tr_b16 v[232:233], v46 offset:16384
  v_mfma_f32_16x16x32_bf16 v[108:111], v[248:251], a[180:183], v[108:111]
  ds_read_b64_tr_b16 v[234:235], v46 offset:17408
  s_waitcnt lgkmcnt(6)
  v_mfma_f32_16x16x32_bf16 v[120:123], v[252:255], a[176:179], v[120:123]
  ds_read_b64_tr_b16 v[236:237], v47 offset:16384
  v_mfma_f32_16x16x32_bf16 v[124:127], v[252:255], a[180:183], v[124:127]
  ds_read_b64_tr_b16 v[238:239], v47 offset:17408
  buffer_load_dwordx4 a[236:239], v28, s[28:31], s76 offen sc1
  v_readlane_b32 s76, v212, 12
  buffer_load_dwordx4 a[240:243], v27, s[28:31], s77 offen sc1
  buffer_load_dwordx4 a[244:247], v28, s[28:31], s77 offen sc1
  v_readlane_b32 s77, v212, 13
  s_waitcnt vmcnt(20)
L_chk1:
  v_xor_b32 v131, s69, v131
  v_xor_b32 v135, s69, v135
  v_xor_b32 v139, s69, v139
  v_xor_b32 v143, s69, v143
  v_or3_b32 v54, v131, v135, v139
  v_or_b32 v54, v54, v143
  v_cmp_lt_u32 vcc, s68, v54
  s_cmp_lg_u64 vcc, 0
  s_cbranch_scc1 L_spin1
L_ok1:
  v_mfma_f32_16x16x32_bf16 v[160:163], v[218:221], v[128:131], 0
  v_mfma_f32_16x16x32_bf16 v[164:167], v[216:219], v[128:131], 0
  v_mfma_f32_16x16x32_bf16 v[160:163], v[218:221], v[132:135], v[160:163]
  buffer_load_dwordx4 a[248:251], v27, s[28:31], s76 offen sc1
  v_mfma_f32_16x16x32_bf16 v[164:167], v[216:219], v[132:135], v[164:167]
  v_mfma_f32_16x16x32_bf16 v[160:163], v[218:221], v[136:139], v[160:163]
  v_mfma_f32_16x16x32_bf16 v[164:167], v[216:219], v[136:139], v[164:167]
  v_mfma_f32_16x16x32_bf16 v[160:163], v[218:221], v[140:143], v[160:163]
  buffer_load_dwordx4 a[252:255], v28, s[28:31], s76 offen sc1
  v_readlane_b32 s76, v212, 14
  v_mfma_f32_16x16x32_bf16 v[164:167], v[216:219], v[140:143], v[164:167]
  s_add_u32 m0, s65, 32768
  s_add_u32 s78, s81, 100352
  buffer_load_dwordx4 v32, s[24:27], s78 offen offset:0 lds
  buffer_load_dwordx4 v36, s[24:27], s78 offen offset:1024 lds
  s_waitcnt vmcnt(20)
L_chk2:
  v_xor_b32 v147, s69, v147
  v_xor_b32 v151, s69, v151
  v_xor_b32 v155, s69, v155
  v_xor_b32 v159, s69, v159
  v_or3_b32 v54, v147, v151, v155
  v_or_b32 v54, v54, v159
  v_cmp_lt_u32 vcc, s68, v54
  s_cmp_lg_u64 vcc, 0
  s_cbranch_scc1 L_spin2
L_ok2:
  v_mfma_f32_16x16x32_bf16 v[160:163], v[218:221], v[144:147], v[160:163]
  v_mfma_f32_16x16x32_bf16 v[164:167], v[216:219], v[144:147], v[164:167]
  v_mfma_f32_16x16x32_bf16 v[160:163], v[218:221], v[148:151], v[160:163]
  buffer_load_dwordx4 v34, s[24:27], s78 offen offset:2048 lds
  v_mfma_f32_16x16x32_bf16 v[164:167], v[216:219], v[148:151], v[164:167]
  v_mfma_f32_16x16x32_bf16 v[160:163], v[218:221], v[152:155], v[160:163]
  v_mfma_f32_16x16x32_bf16 v[164:167], v[216:219], v[152:155], v[164:167]
  v_mfma_f32_16x16x32_bf16 v[160:163], v[218:221], v[156:159], v[160:163]
  s_waitcnt vmcnt(19)
  buffer_load_dwordx4 v37, s[24:27], s78 offen offset:3072 lds
  v_mfma_f32_16x16x32_bf16 v[164:167], v[216:219], v[156:159], v[164:167]
  s_waitcnt lgkmcnt(6)
  v_mfma_f32_16x16x32_bf16 v[72:75], v[224:227], a[184:187], v[72:75]
  ds_read_b64_tr_b16 v[240:241], v44 offset:20480
  v_mfma_f32_16x16x32_bf16 v[76:79], v[224:227], a[188:191], v[76:79]
  buffer_load_dwordx4 a[176:179], v27, s[28:31], s77 offen sc1
  ds_read_b64_tr_b16 v[242:243], v44 offset:21504
  s_waitcnt lgkmcnt(6)
  v_mfma_f32_16x16x32_bf16 v[88:91], v[228:231], a[184:187], v[88:91]
  ds_read_b64_tr_b16 v[244:245], v45 offset:20480
  v_cvt_pk_bf16_f32 v160, v160, v161
  v_mfma_f32_16x16x32_bf16 v[92:95], v[228:231], a[188:191], v[92:95]
  ds_read_b64_tr_b16 v[246:247], v45 offset:21504
  v_cvt_pk_bf16_f32 v161, v162, v163
  s_waitcnt lgkmcnt(6)
  v_mfma_f32_16x16x32_bf16 v[104:107], v[232:235], a[184:187], v[104:107]
  ds_read_b64_tr_b16 v[248:249], v46 offset:20480
  v_cvt_pk_bf16_f32 v162, v164, v165
  v_mfma_f32_16x16x32_bf16 v[108:111], v[232:235], a[188:191], v[108:111]
  ds_read_b64_tr_b16 v[250:251], v46 offset:21504
  buffer_load_dwordx4 a[180:183], v28, s[28:31], s77 offen sc1
  v_readlane_b32 s77, v212, 15
  s_waitcnt lgkmcnt(6)
  v_mfma_f32_16x16x32_bf16 v[120:123], v[236:239], a[184:187], v[120:123]
  ds_read_b64_tr_b16 v[252:253], v47 offset:20480
  v_cvt_pk_bf16_f32 v163, v166, v167
  v_mfma_f32_16x16x32_bf16 v[124:127], v[236:239], a[188:191], v[124:127]
  ds_read_b64_tr_b16 v[254:255], v47 offset:21504
  s_waitcnt vmcnt(20)
  ds_write_b128 v59, v[160:163]
  s_waitcnt lgkmcnt(7)
  v_mfma_f32_16x16x32_bf16 v[72:75], v[240:243], a[192:195], v[72:75]
  ds_read_b64_tr_b16 v[224:225], v44 offset:24576
  buffer_load_dwordx4 a[184:187], v27, s[28:31], s76 offen sc1
  v_mfma_f32_16x16x32_bf16 v[76:79], v[240:243], a[196:199], v[76:79]
  ds_read_b64_tr_b16 v[226:227], v44 offset:25600
  s_waitcnt lgkmcnt(2)
  v_mfma_f32_16x16x32_bf16 v[88:91], v[244:247], a[192:195], v[88:91]
  ds_read_b64_tr_b16 v[228:229], v45 offset:24576
  s_barrier
  buffer_load_dwordx4 a[188:191], v28, s[28:31], s76 offen sc1
  v_readlane_b32 s76, v212, 16
  v_mfma_f32_16x16x32_bf16 v[92:95], v[244:247], a[196:199], v[92:95]
  ds_read_b64_tr_b16 v[230:231], v45 offset:25600
  ds_read_b128 v[168:171], v25 offset:28672
  v_mfma_f32_16x16x32_bf16 v[104:107], v[248:251], a[192:195], v[104:107]
  ds_read_b64_tr_b16 v[232:233], v46 offset:24576
  ds_read_b128 v[172:175], v25 offset:29696
  v_mfma_f32_16x16x32_bf16 v[108:111], v[248:251], a[196:199], v[108:111]
  ds_read_b64_tr_b16 v[234:235], v46 offset:25600
  ds_read_b128 v[176:179], v25 offset:30720
  v_mfma_f32_16x16x32_bf16 v[120:123], v[252:255], a[192:195], v[120:123]
  ds_read_b64_tr_b16 v[236:237], v47 offset:24576
  s_add_u32 s75, s46, 24
  v_readlane_b32 s79, v22, s75
  s_add_u32 m0, s65, 0
  s_nop 3
  buffer_load_dwordx4 v32, s[20:23], s79 offen offset:0 lds
  v_mfma_f32_16x16x32_bf16 v[124:127], v[252:255], a[196:199], v[124:127]
  ds_read_b64_tr_b16 v[238:239], v47 offset:25600
  s_waitcnt vmcnt(21)
  ds_read_b128 v[180:183], v25 offset:31744
  s_waitcnt lgkmcnt(10)
  v_mfma_f32_16x16x32_bf16 v[72:75], v[224:227], a[200:203], v[72:75]
  ds_read_b64_tr_b16 v[240:241], v44 offset:28672
  v_mfma_f32_16x16x32_bf16 v[76:79], v[224:227], a[204:207], v[76:79]
  buffer_load_dwordx4 v33, s[20:23], s79 offen offset:1024 lds
  ds_read_b64_tr_b16 v[242:243], v44 offset:29696
  s_waitcnt lgkmcnt(10)
  v_mfma_f32_16x16x32_bf16 v[88:91], v[228:231], a[200:203], v[88:91]
  ds_read_b64_tr_b16 v[244:245], v45 offset:28672
  v_mfma_f32_16x16x32_bf16 v[92:95], v[228:231], a[204:207], v[92:95]
  ds_read_b64_tr_b16 v[246:247], v45 offset:29696
  s_waitcnt lgkmcnt(8)
  v_mfma_f32_16x16x32_bf16 v[104:107], v[232:235], a[200:203], v[104:107]
  buffer_load_dwordx4 v34, s[20:23], s79 offen offset:2048 lds
  ds_read_b64_tr_b16 v[248:249], v46 offset:28672
  v_mfma_f32_16x16x32_bf16 v[108:111], v[232:235], a[204:207], v[108:111]
  ds_read_b64_tr_b16 v[250:251], v46 offset:29696
  s_waitcnt lgkmcnt(7)
  v_mfma_f32_16x16x32_bf16 v[120:123], v[236:239], a[200:203], v[120:123]
  ds_read_b64_tr_b16 v[252:253], v47 offset:28672
  v_mfma_f32_16x16x32_bf16 v[124:127], v[236:239], a[204:207], v[124:127]
  buffer_load_dwordx4 v35, s[20:23], s79 offen offset:3072 lds
  ds_read_b64_tr_b16 v[254:255], v47 offset:29696
  s_waitcnt vmcnt(22)
  s_waitcnt lgkmcnt(6)
  v_mfma_f32_16x16x32_bf16 v[72:75], v[240:243], a[208:211], v[72:75]
  ds_read_b64_tr_b16 v[224:225], v40 offset:49152
  v_mfma_f32_16x16x32_bf16 v[76:79], v[240:243], a[212:215], v[76:79]
  ds_read_b64_tr_b16 v[226:227], v40 offset:50176
  v_mfma_f32_16x16x32_bf16 v[132:135], v[172:175], v[192:195], 0
  v_mfma_f32_16x16x32_bf16 v[128:131], v[168:171], v[192:195], 0
  v_mfma_f32_16x16x32_bf16 v[140:143], v[172:175], v[196:199], 0
  v_mfma_f32_16x16x32_bf16 v[136:139], v[168:171], v[196:199], 0
  v_mfma_f32_16x16x32_bf16 v[132:135], v[180:183], v[192:195], v[132:135]
  buffer_load_dwordx4 a[192:195], v27, s[28:31], s77 offen sc1
  v_mfma_f32_16x16x32_bf16 v[128:131], v[176:179], v[192:195], v[128:131]
  v_mfma_f32_16x16x32_bf16 v[140:143], v[180:183], v[196:199], v[140:143]
  v_mfma_f32_16x16x32_bf16 v[136:139], v[176:179], v[196:199], v[136:139]
  buffer_load_dwordx4 a[196:199], v28, s[28:31], s77 offen sc1
  v_readlane_b32 s77, v212, 17
  s_waitcnt lgkmcnt(6)
  v_mfma_f32_16x16x32_bf16 v[88:91], v[244:247], a[208:211], v[88:91]
  ds_read_b64_tr_b16 v[228:229], v41 offset:49152
  v_mfma_f32_16x16x32_bf16 v[92:95], v[244:247], a[212:215], v[92:95]
  ds_read_b64_tr_b16 v[230:231], v41 offset:50176
  v_add_f32 v2, s64, v135
  s_waitcnt lgkmcnt(6)
  v_mfma_f32_16x16x32_bf16 v[104:107], v[248:251], a[208:211], v[104:107]
  buffer_load_dwordx4 a[200:203], v27, s[28:31], s76 offen sc1
  ds_read_b64_tr_b16 v[232:233], v42 offset:49152
  v_mfma_f32_16x16x32_bf16 v[108:111], v[248:251], a[212:215], v[108:111]
  ds_read_b64_tr_b16 v[234:235], v42 offset:50176
  v_add_f32 v4, s64, v143
  s_waitcnt lgkmcnt(6)
  v_mfma_f32_16x16x32_bf16 v[120:123], v[252:255], a[208:211], v[120:123]
  ds_read_b64_tr_b16 v[236:237], v43 offset:49152
  v_rcp_f32 v2, v2
  v_mfma_f32_16x16x32_bf16 v[124:127], v[252:255], a[212:215], v[124:127]
  ds_read_b64_tr_b16 v[238:239], v43 offset:50176
  s_waitcnt vmcnt(23)
  v_rcp_f32 v4, v4
  s_waitcnt lgkmcnt(6)
  v_mfma_f32_16x16x32_bf16 v[72:75], v[224:227], a[216:219], v[72:75]
  ds_read_b64_tr_b16 v[240:241], v40 offset:53248
  v_mul_f32 v2, v2, v62
  v_mfma_f32_16x16x32_bf16 v[76:79], v[224:227], a[220:223], v[76:79]
  ds_read_b64_tr_b16 v[242:243], v40 offset:54272
  v_mul_f32 v4, v4, v63
  s_waitcnt lgkmcnt(6)
  v_mfma_f32_16x16x32_bf16 v[88:91], v[228:231], a[216:219], v[88:91]
  buffer_load_dwordx4 a[204:207], v28, s[28:31], s76 offen sc1
  v_readlane_b32 s76, v212, 18
  ds_read_b64_tr_b16 v[244:245], v41 offset:53248
  v_mfma_f32_16x16x32_bf16 v[92:95], v[228:231], a[220:223], v[92:95]
  ds_read_b64_tr_b16 v[246:247], v41 offset:54272
  v_mul_f32 v128, v128, v2
  s_waitcnt lgkmcnt(6)
  v_mfma_f32_16x16x32_bf16 v[104:107], v[232:235], a[216:219], v[104:107]
  ds_read_b64_tr_b16 v[248:249], v42 offset:53248
  v_mul_f32 v129, v129, v2
  v_mfma_f32_16x16x32_bf16 v[108:111], v[232:235], a[220:223], v[108:111]
  ds_read_b64_tr_b16 v[250:251], v42 offset:54272
  v_mul_f32 v130, v130, v2
  s_waitcnt lgkmcnt(6)
  v_mfma_f32_16x16x32_bf16 v[120:123], v[236:239], a[216:219], v[120:123]
  buffer_load_dwordx4 a[208:211], v27, s[28:31], s77 offen sc1
  ds_read_b64_tr_b16 v[252:253], v43 offset:53248
  v_mfma_f32_16x16x32_bf16 v[124:127], v[236:239], a[220:223], v[124:127]
  ds_read_b64_tr_b16 v[254:255], v43 offset:54272
  s_waitcnt vmcnt(23)
  v_mul_f32 v131, v131, v2
  s_waitcnt lgkmcnt(6)
  v_mfma_f32_16x16x32_bf16 v[72:75], v[240:243], a[224:227], v[72:75]
  ds_read_b64_tr_b16 v[224:225], v40 offset:57344
  v_mul_f32 v132, v132, v2
  v_mfma_f32_16x16x32_bf16 v[76:79], v[240:243], a[228:231], v[76:79]
  ds_read_b64_tr_b16 v[226:227], v40 offset:58368
  v_mul_f32 v133, v133, v2
  s_waitcnt lgkmcnt(6)
  v_mfma_f32_16x16x32_bf16 v[88:91], v[244:247], a[224:227], v[88:91]
  ds_read_b64_tr_b16 v[228:229], v41 offset:57344
  buffer_load_dwordx4 a[212:215], v28, s[28:31], s77 offen sc1
  v_readlane_b32 s77, v212, 19
  v_mfma_f32_16x16x32_bf16 v[92:95], v[244:247], a[228:231], v[92:95]
  ds_read_b64_tr_b16 v[230:231], v41 offset:58368
  v_mul_f32 v134, v134, v2
  s_waitcnt lgkmcnt(6)
  v_mfma_f32_16x16x32_bf16 v[104:107], v[248:251], a[224:227], v[104:107]
  ds_read_b64_tr_b16 v[232:233], v42 offset:57344
  v_mul_f32 v135, v135, v2
  v_mfma_f32_16x16x32_bf16 v[108:111], v[248:251], a[228:231], v[108:111]
  ds_read_b64_tr_b16 v[234:235], v42 offset:58368
  v_cvt_pk_bf16_f32 v128, v128, v129
  s_waitcnt lgkmcnt(6)
  v_mfma_f32_16x16x32_bf16 v[120:123], v[252:255], a[224:227], v[120:123]
  ds_read_b64_tr_b16 v[236:237], v43 offset:57344
  v_cvt_pk_bf16_f32 v129, v130, v131
  v_mfma_f32_16x16x32_bf16 v[124:127], v[252:255], a[228:231], v[124:127]
  ds_read_b64_tr_b16 v[238:239], v43 offset:58368
  buffer_load_dwordx4 a[216:219], v27, s[28:31], s76 offen sc1
  s_waitcnt vmcnt(23)
  s_waitcnt lgkmcnt(6)
  v_mfma_f32_16x16x32_bf16 v[72:75], v[224:227], a[232:235], v[72:75]
  ds_read_b64_tr_b16 v[240:241], v40 offset:61440
  v_cvt_pk_bf16_f32 v130, v132, v133
  v_mfma_f32_16x16x32_bf16 v[76:79], v[224:227], a[236:239], v[76:79]
  ds_read_b64_tr_b16 v[242:243], v40 offset:62464
  v_cvt_pk_bf16_f32 v131, v134, v135
  s_waitcnt lgkmcnt(6)
  v_mfma_f32_16x16x32_bf16 v[88:91], v[228:231], a[232:235], v[88:91]
  ds_read_b64_tr_b16 v[244:245], v41 offset:61440
  v_and_or_b32 v131, v131, s68, v213
  v_mfma_f32_16x16x32_bf16 v[92:95], v[228:231], a[236:239], v[92:95]
  ds_read_b64_tr_b16 v[246:247], v41 offset:62464
  buffer_load_dwordx4 a[220:223], v28, s[28:31], s76 offen sc1
  v_readlane_b32 s76, v212, 20
  s_waitcnt lgkmcnt(6)
  v_mfma_f32_16x16x32_bf16 v[104:107], v[232:235], a[232:235], v[104:107]
  ds_read_b64_tr_b16 v[248:249], v42 offset:61440
  v_mul_f32 v136, v136, v4
  v_mfma_f32_16x16x32_bf16 v[108:111], v[232:235], a[236:239], v[108:111]
  ds_read_b64_tr_b16 v[250:251], v42 offset:62464
  v_mul_f32 v137, v137, v4
  s_waitcnt lgkmcnt(6)
  v_mfma_f32_16x16x32_bf16 v[120:123], v[236:239], a[232:235], v[120:123]
  ds_read_b64_tr_b16 v[252:253], v43 offset:61440
  v_mul_f32 v138, v138, v4
  v_mfma_f32_16x16x32_bf16 v[124:127], v[236:239], a[236:239], v[124:127]
  ds_read_b64_tr_b16 v[254:255], v43 offset:62464
  buffer_store_dwordx4 v[128:131], v27, s[28:31], s74 offen offset:0 sc1
  s_waitcnt vmcnt(23)
  v_mul_f32 v139, v139, v4
  v_mul_f32 v140, v140, v4
  v_mul_f32 v141, v141, v4
  v_mul_f32 v142, v142, v4
  v_mul_f32 v143, v143, v4
  v_cvt_pk_bf16_f32 v136, v136, v137
  v_cvt_pk_bf16_f32 v137, v138, v139
  v_cvt_pk_bf16_f32 v138, v140, v141
  v_cvt_pk_bf16_f32 v139, v142, v143
  v_and_or_b32 v139, v139, s68, v213
  buffer_store_dwordx4 v[136:139], v28, s[28:31], s74 offen offset:0 sc1
  buffer_load_dwordx4 a[224:227], v27, s[28:31], s77 offen sc1
  s_waitcnt vmcnt(19)
  buffer_load_dwordx4 a[228:231], v28, s[28:31], s77 offen sc1
  v_readlane_b32 s77, v212, 21
  s_waitcnt lgkmcnt(0)
  s_barrier
  v_mfma_f32_16x16x32_bf16 v[72:75], v[240:243], a[240:243], v[72:75]
  buffer_load_dwordx4 a[232:235], v27, s[28:31], s76 offen sc1
  ds_read_b64_tr_b16 v[224:225], v44 offset:32768
  v_mfma_f32_16x16x32_bf16 v[76:79], v[240:243], a[244:247], v[76:79]
  ds_read_b64_tr_b16 v[226:227], v44 offset:33792
  ds_read_b64_tr_b16 a[0:1], v40 offset:16384
  v_mfma_f32_16x16x32_bf16 v[88:91], v[244:247], a[240:243], v[88:91]
  ds_read_b64_tr_b16 v[228:229], v45 offset:32768
  ds_read_b64_tr_b16 a[2:3], v40 offset:17408
  v_mfma_f32_16x16x32_bf16 v[92:95], v[244:247], a[244:247], v[92:95]
  ds_read_b64_tr_b16 v[230:231], v45 offset:33792
  ds_read_b64_tr_b16 a[4:5], v41 offset:16384
  v_mfma_f32_16x16x32_bf16 v[104:107], v[248:251], a[240:243], v[104:107]
  ds_read_b64_tr_b16 v[232:233], v46 offset:32768
  buffer_load_dwordx4 a[236:239], v28, s[28:31], s76 offen sc1
  v_readlane_b32 s76, v212, 22
  v_mfma_f32_16x16x32_bf16 v[108:111], v[248:251], a[244:247], v[108:111]
  ds_read_b64_tr_b16 v[234:235], v46 offset:33792
  ds_read_b64_tr_b16 a[6:7], v41 offset:17408
  v_mfma_f32_16x16x32_bf16 v[120:123], v[252:255], a[240:243], v[120:123]
  ds_read_b64_tr_b16 v[236:237], v47 offset:32768
  ds_read_b64_tr_b16 a[8:9], v42 offset:16384
  v_mfma_f32_16x16x32_bf16 v[124:127], v[252:255], a[244:247], v[124:127]
  ds_read_b64_tr_b16 v[238:239], v47 offset:33792
  ds_read_b64_tr_b16 a[10:11], v42 offset:17408
  s_waitcnt lgkmcnt(12)
  v_mfma_f32_16x16x32_bf16 v[72:75], v[224:227], a[248:251], v[72:75]
  ds_read_b64_tr_b16 v[240:241], v44 offset:36864
  ds_read_b64_tr_b16 a[12:13], v43 offset:16384
  buffer_load_dwordx4 a[240:243], v27, s[28:31], s77 offen sc1
  v_mfma_f32_16x16x32_bf16 v[76:79], v[224:227], a[252:255], v[76:79]
  ds_read_b64_tr_b16 v[242:243], v44 offset:37888
  ds_read_b64_tr_b16 a[14:15], v43 offset:17408
  s_waitcnt lgkmcnt(12)
  v_mfma_f32_16x16x32_bf16 v[88:91], v[228:231], a[248:251], v[88:91]
  ds_read_b64_tr_b16 v[244:245], v45 offset:36864
  ds_read_b64_tr_b16 a[16:17], v40 offset:20480
  v_mfma_f32_16x16x32_bf16 v[92:95], v[228:231], a[252:255], v[92:95]
  ds_read_b64_tr_b16 v[246:247], v45 offset:37888
  ds_read_b64_tr_b16 a[18:19], v40 offset:21504
  s_waitcnt lgkmcnt(13)
  v_mfma_f32_16x16x32_bf16 v[104:107], v[232:235], a[248:251], v[104:107]
  ds_read_b64_tr_b16 v[248:249], v46 offset:36864
  ds_read_b64_tr_b16 a[20:21], v41 offset:20480
  v_mfma_f32_16x16x32_bf16 v[108:111], v[232:235], a[252:255], v[108:111]
  buffer_load_dwordx4 a[244:247], v28, s[28:31], s77 offen sc1
  v_readlane_b32 s77, v212, 23
  ds_read_b64_tr_b16 v[250:251], v46 offset:37888
  s_waitcnt lgkmcnt(12)
  v_mfma_f32_16x16x32_bf16 v[120:123], v[236:239], a[248:251], v[120:123]
  ds_read_b64_tr_b16 v[252:253], v47 offset:36864
  ds_read_b64_tr_b16 a[22:23], v41 offset:21504
  v_mfma_f32_16x16x32_bf16 v[124:127], v[236:239], a[252:255], v[124:127]
  ds_read_b64_tr_b16 v[254:255], v47 offset:37888
  s_waitcnt vmcnt(22)
  ds_read_b64_tr_b16 a[24:25], v42 offset:20480
  s_waitcnt lgkmcnt(12)
  v_mfma_f32_16x16x32_bf16 v[72:75], v[240:243], a[176:179], v[72:75]
  ds_read_b64_tr_b16 v[224:225], v44 offset:40960
  ds_read_b64_tr_b16 a[26:27], v42 offset:21504
  v_mfma_f32_16x16x32_bf16 v[76:79], v[240:243], a[180:183], v[76:79]
  buffer_load_dwordx4 a[248:251], v27, s[28:31], s76 offen sc1
  ds_read_b64_tr_b16 v[226:227], v44 offset:41984
  s_waitcnt lgkmcnt(11)
  v_mfma_f32_16x16x32_bf16 v[88:91], v[244:247], a[176:179], v[88:91]
  ds_read_b64_tr_b16 v[228:229], v45 offset:40960
  ds_read_b64_tr_b16 a[28:29], v43 offset:20480
  v_mfma_f32_16x16x32_bf16 v[92:95], v[244:247], a[180:183], v[92:95]
  ds_read_b64_tr_b16 v[230:231], v45 offset:41984
  ds_read_b64_tr_b16 a[30:31], v43 offset:21504
  s_waitcnt lgkmcnt(11)
  v_mfma_f32_16x16x32_bf16 v[104:107], v[248:251], a[176:179], v[104:107]
  ds_read_b64_tr_b16 v[232:233], v46 offset:40960
  ds_read_b64_tr_b16 a[32:33], v40 offset:24576
  v_mfma_f32_16x16x32_bf16 v[108:111], v[248:251], a[180:183], v[108:111]
  ds_read_b64_tr_b16 v[234:235], v46 offset:41984
  buffer_load_dwordx4 a[252:255], v28, s[28:31], s76 offen sc1
  v_readlane_b32 s76, v212, 24
  s_waitcnt lgkmcnt(11)
  v_mfma_f32_16x16x32_bf16 v[120:123], v[252:255], a[176:179], v[120:123]
  ds_read_b64_tr_b16 v[236:237], v47 offset:40960
  ds_read_b64_tr_b16 a[34:35], v40 offset:25600
  v_mfma_f32_16x16x32_bf16 v[124:127], v[252:255], a[180:183], v[124:127]
  ds_read_b64_tr_b16 v[238:239], v47 offset:41984
  s_waitcnt vmcnt(22)
  ds_read_b64_tr_b16 a[36:37], v41 offset:24576
  s_waitcnt lgkmcnt(11)
  v_mfma_f32_16x16x32_bf16 v[72:75], v[224:227], a[184:187], v[72:75]
  ds_read_b64_tr_b16 v[240:241], v44 offset:45056
  ds_read_b64_tr_b16 a[38:39], v41 offset:25600
  v_mfma_f32_16x16x32_bf16 v[76:79], v[224:227], a[188:191], v[76:79]
  ds_read_b64_tr_b16 v[242:243], v44 offset:46080
  s_add_u32 m0, s65, 65536
  s_add_u32 s78, s81, 200704
  buffer_load_dwordx4 v32, s[24:27], s78 offen offset:0 lds
  s_waitcnt lgkmcnt(11)
  v_mfma_f32_16x16x32_bf16 v[88:91], v[228:231], a[184:187], v[88:91]
  ds_read_b64_tr_b16 v[244:245], v45 offset:45056
  ds_read_b64_tr_b16 a[40:41], v42 offset:24576
  v_mfma_f32_16x16x32_bf16 v[92:95], v[228:231], a[188:191], v[92:95]
  ds_read_b64_tr_b16 v[246:247], v45 offset:46080
  ds_read_b64_tr_b16 a[42:43], v42 offset:25600
  s_waitcnt lgkmcnt(11)
  v_mfma_f32_16x16x32_bf16 v[104:107], v[232:235], a[184:187], v[104:107]
  ds_read_b64_tr_b16 v[248:249], v46 offset:45056
  ds_read_b64_tr_b16 a[44:45], v43 offset:24576
  v_mfma_f32_16x16x32_bf16 v[108:111], v[232:235], a[188:191], v[108:111]
  ds_read_b64_tr_b16 v[250:251], v46 offset:46080
  buffer_load_dwordx4 v36, s[24:27], s78 offen offset:1024 lds
  s_waitcnt lgkmcnt(11)
  v_mfma_f32_16x16x32_bf16 v[120:123], v[236:239], a[184:187], v[120:123]
  ds_read_b64_tr_b16 v[252:253], v47 offset:45056
  ds_read_b64_tr_b16 a[46:47], v43 offset:25600
  v_mfma_f32_16x16x32_bf16 v[124:127], v[236:239], a[188:191], v[124:127]
  ds_read_b64_tr_b16 v[254:255], v47 offset:46080
  ds_read_b64_tr_b16 a[48:49], v40 offset:28672
  ds_read_b64_tr_b16 a[50:51], v40 offset:29696
  ds_read_b64_tr_b16 a[52:53], v41 offset:28672
  ds_read_b64_tr_b16 a[54:55], v41 offset:29696
  ds_read_b64_tr_b16 a[56:57], v42 offset:28672
  ds_read_b64_tr_b16 a[58:59], v42 offset:29696
  ds_read_b64_tr_b16 a[60:61], v43 offset:28672
  ds_read_b64_tr_b16 a[62:63], v43 offset:29696
  buffer_load_dwordx4 v34, s[24:27], s78 offen offset:2048 lds
  s_waitcnt vmcnt(19)
  buffer_load_dwordx4 v37, s[24:27], s78 offen offset:3072 lds
  s_waitcnt lgkmcnt(15)
  v_mfma_f32_16x16x32_bf16 v[72:75], v[240:243], a[192:195], v[72:75]
  ds_read_b64_tr_b16 v[224:225], v44 offset:49152
  v_mfma_f32_16x16x32_bf16 v[76:79], v[240:243], a[196:199], v[76:79]
  ds_read_b64_tr_b16 v[226:227], v44 offset:50176
  s_waitcnt lgkmcnt(15)
  v_mfma_f32_16x16x32_bf16 v[88:91], v[244:247], a[192:195], v[88:91]
  ds_read_b64_tr_b16 v[228:229], v45 offset:49152
  v_mfma_f32_16x16x32_bf16 v[92:95], v[244:247], a[196:199], v[92:95]
  ds_read_b64_tr_b16 v[230:231], v45 offset:50176
  buffer_load_dwordx4 a[176:179], v27, s[28:31], s77 offen sc1
  s_waitcnt lgkmcnt(15)
  v_mfma_f32_16x16x32_bf16 v[104:107], v[248:251], a[192:195], v[104:107]
  ds_read_b64_tr_b16 v[232:233], v46 offset:49152
  v_mfma_f32_16x16x32_bf16 v[108:111], v[248:251], a[196:199], v[108:111]
  ds_read_b64_tr_b16 v[234:235], v46 offset:50176
  s_waitcnt lgkmcnt(14)
  v_mfma_f32_16x16x32_bf16 v[120:123], v[252:255], a[192:195], v[120:123]
  ds_read_b64_tr_b16 v[236:237], v47 offset:49152
  v_mfma_f32_16x16x32_bf16 v[124:127], v[252:255], a[196:199], v[124:127]
  ds_read_b64_tr_b16 v[238:239], v47 offset:50176
  s_waitcnt vmcnt(19)
  buffer_load_dwordx4 a[180:183], v28, s[28:31], s77 offen sc1
  v_readlane_b32 s77, v212, 25
  s_waitcnt lgkmcnt(6)
  v_mfma_f32_16x16x32_bf16 v[72:75], v[224:227], a[200:203], v[72:75]
  ds_read_b64_tr_b16 v[240:241], v44 offset:53248
  v_mfma_f32_16x16x32_bf16 v[76:79], v[224:227], a[204:207], v[76:79]
  ds_read_b64_tr_b16 v[242:243], v44 offset:54272
  s_waitcnt lgkmcnt(6)
  v_mfma_f32_16x16x32_bf16 v[88:91], v[228:231], a[200:203], v[88:91]
  ds_read_b64_tr_b16 v[244:245], v45 offset:53248
  v_mfma_f32_16x16x32_bf16 v[92:95], v[228:231], a[204:207], v[92:95]
  ds_read_b64_tr_b16 v[246:247], v45 offset:54272
  buffer_load_dwordx4 a[184:187], v27, s[28:31], s76 offen sc1
  s_waitcnt lgkmcnt(6)
  v_mfma_f32_16x16x32_bf16 v[104:107], v[232:235], a[200:203], v[104:107]
  ds_read_b64_tr_b16 v[248:249], v46 offset:53248
  v_mfma_f32_16x16x32_bf16 v[108:111], v[232:235], a[204:207], v[108:111]
  ds_read_b64_tr_b16 v[250:251], v46 offset:54272
  s_waitcnt lgkmcnt(6)
  v_mfma_f32_16x16x32_bf16 v[120:123], v[236:239], a[200:203], v[120:123]
  ds_read_b64_tr_b16 v[252:253], v47 offset:53248
  v_mfma_f32_16x16x32_bf16 v[124:127], v[236:239], a[204:207], v[124:127]
  ds_read_b64_tr_b16 v[254:255], v47 offset:54272
  s_waitcnt vmcnt(19)
  buffer_load_dwordx4 a[188:191], v28, s[28:31], s76 offen sc1
  v_readlane_b32 s76, v212, 26
  s_waitcnt lgkmcnt(6)
  v_mfma_f32_16x16x32_bf16 v[72:75], v[240:243], a[208:211], v[72:75]
  ds_read_b64_tr_b16 v[224:225], v44 offset:57344
  v_mfma_f32_16x16x32_bf16 v[76:79], v[240:243], a[212:215], v[76:79]
  ds_read_b64_tr_b16 v[226:227], v44 offset:58368
  s_waitcnt lgkmcnt(6)
  v_mfma_f32_16x16x32_bf16 v[88:91], v[244:247], a[208:211], v[88:91]
  ds_read_b64_tr_b16 v[228:229], v45 offset:57344
  v_mfma_f32_16x16x32_bf16 v[92:95], v[244:247], a[212:215], v[92:95]
  ds_read_b64_tr_b16 v[230:231], v45 offset:58368
  s_waitcnt lgkmcnt(6)
  v_mfma_f32_16x16x32_bf16 v[104:107], v[248:251], a[208:211], v[104:107]
  ds_read_b64_tr_b16 v[232:233], v46 offset:57344
  s_add_u32 m0, s65, 81920
  s_add_u32 s78, s81, 301056
  buffer_load_dwordx4 v32, s[24:27], s78 offen offset:0 lds
  v_mfma_f32_16x16x32_bf16 v[108:111], v[248:251], a[212:215], v[108:111]
  ds_read_b64_tr_b16 v[234:235], v46 offset:58368
  s_waitcnt lgkmcnt(6)
  v_mfma_f32_16x16x32_bf16 v[120:123], v[252:255], a[208:211], v[120:123]
  ds_read_b64_tr_b16 v[236:237], v47 offset:57344
  v_mfma_f32_16x16x32_bf16 v[124:127], v[252:255], a[212:215], v[124:127]
  ds_read_b64_tr_b16 v[238:239], v47 offset:58368
  s_waitcnt vmcnt(19)
  buffer_load_dwordx4 v36, s[24:27], s78 offen offset:1024 lds
  s_waitcnt lgkmcnt(6)
  v_mfma_f32_16x16x32_bf16 v[72:75], v[224:227], a[216:219], v[72:75]
  ds_read_b64_tr_b16 v[240:241], v44 offset:61440
  v_mfma_f32_16x16x32_bf16 v[76:79], v[224:227], a[220:223], v[76:79]
  ds_read_b64_tr_b16 v[242:243], v44 offset:62464
  s_waitcnt lgkmcnt(6)
  v_mfma_f32_16x16x32_bf16 v[88:91], v[228:231], a[216:219], v[88:91]
  ds_read_b64_tr_b16 v[244:245], v45 offset:61440
  v_mfma_f32_16x16x32_bf16 v[92:95], v[228:231], a[220:223], v[92:95]
  ds_read_b64_tr_b16 v[246:247], v45 offset:62464
  buffer_load_dwordx4 v34, s[24:27], s78 offen offset:2048 lds
  s_waitcnt lgkmcnt(6)
  v_mfma_f32_16x16x32_bf16 v[104:107], v[232:235], a[216:219], v[104:107]
  ds_read_b64_tr_b16 v[248:249], v46 offset:61440
  v_mfma_f32_16x16x32_bf16 v[108:111], v[232:235], a[220:223], v[108:111]
  ds_read_b64_tr_b16 v[250:251], v46 offset:62464
  s_waitcnt lgkmcnt(6)
  v_mfma_f32_16x16x32_bf16 v[120:123], v[236:239], a[216:219], v[120:123]
  ds_read_b64_tr_b16 v[252:253], v47 offset:61440
  v_mfma_f32_16x16x32_bf16 v[124:127], v[236:239], a[220:223], v[124:127]
  ds_read_b64_tr_b16 v[254:255], v47 offset:62464
  buffer_load_dwordx4 v37, s[24:27], s78 offen offset:3072 lds
  buffer_load_dwordx4 a[192:195], v27, s[28:31], s77 offen sc1
  s_waitcnt vmcnt(19)
  buffer_load_dwordx4 a[196:199], v28, s[28:31], s77 offen sc1
  v_readlane_b32 s77, v212, 27
  s_waitcnt lgkmcnt(6)
  v_mfma_f32_16x16x32_bf16 v[72:75], v[240:243], a[224:227], v[72:75]
  ds_read_b64_tr_b16 v[224:225], v48 offset:0
  v_mfma_f32_16x16x32_bf16 v[76:79], v[240:243], a[228:231], v[76:79]
  ds_read_b64_tr_b16 v[226:227], v48 offset:1024
  s_waitcnt lgkmcnt(6)
  v_mfma_f32_16x16x32_bf16 v[88:91], v[244:247], a[224:227], v[88:91]
  ds_read_b64_tr_b16 v[228:229], v49 offset:0
  v_mfma_f32_16x16x32_bf16 v[92:95], v[244:247], a[228:231], v[92:95]
  buffer_load_dwordx4 a[204:207], v28, s[28:31], s76 offen sc1
  v_readlane_b32 s76, v212, 26
  ds_read_b64_tr_b16 v[230:231], v49 offset:1024
  s_waitcnt lgkmcnt(6)
  v_mfma_f32_16x16x32_bf16 v[104:107], v[248:251], a[224:227], v[104:107]
  ds_read_b64_tr_b16 v[232:233], v50 offset:0
  v_mfma_f32_16x16x32_bf16 v[108:111], v[248:251], a[228:231], v[108:111]
  ds_read_b64_tr_b16 v[234:235], v50 offset:1024
  s_waitcnt lgkmcnt(6)
  v_mfma_f32_16x16x32_bf16 v[120:123], v[252:255], a[224:227], v[120:123]
  ds_read_b64_tr_b16 v[236:237], v51 offset:0
  v_mfma_f32_16x16x32_bf16 v[124:127], v[252:255], a[228:231], v[124:127]
  buffer_load_dwordx4 a[212:215], v28, s[28:31], s77 offen sc1
  v_readlane_b32 s77, v212, 27
  ds_read_b64_tr_b16 v[238:239], v51 offset:1024
  s_waitcnt vmcnt(20)
  s_waitcnt lgkmcnt(6)
  v_mfma_f32_16x16x32_bf16 v[72:75], v[224:227], a[232:235], v[72:75]
  ds_read_b64_tr_b16 v[240:241], v48 offset:4096
  v_mfma_f32_16x16x32_bf16 v[76:79], v[224:227], a[236:239], v[76:79]
  ds_read_b64_tr_b16 v[242:243], v48 offset:5120
  s_waitcnt lgkmcnt(6)
  v_mfma_f32_16x16x32_bf16 v[88:91], v[228:231], a[232:235], v[88:91]
  ds_read_b64_tr_b16 v[244:245], v49 offset:4096
  v_mfma_f32_16x16x32_bf16 v[92:95], v[228:231], a[236:239], v[92:95]
  buffer_load_dwordx4 a[200:203], v27, s[28:31], s76 offen sc1
  ds_read_b64_tr_b16 v[246:247], v49 offset:5120
  s_waitcnt lgkmcnt(6)
  v_mfma_f32_16x16x32_bf16 v[104:107], v[232:235], a[232:235], v[104:107]
  ds_read_b64_tr_b16 v[248:249], v50 offset:4096
  v_mfma_f32_16x16x32_bf16 v[108:111], v[232:235], a[236:239], v[108:111]
  ds_read_b64_tr_b16 v[250:251], v50 offset:5120
  s_waitcnt lgkmcnt(6)
  v_mfma_f32_16x16x32_bf16 v[120:123], v[236:239], a[232:235], v[120:123]
  ds_read_b64_tr_b16 v[252:253], v51 offset:4096
  v_mfma_f32_16x16x32_bf16 v[124:127], v[236:239], a[236:239], v[124:127]
  ds_read_b64_tr_b16 v[254:255], v51 offset:5120
  s_waitcnt vmcnt(19)
  buffer_load_dwordx4 a[208:211], v27, s[28:31], s77 offen sc1
  s_waitcnt lgkmcnt(6)
  v_mfma_f32_16x16x32_bf16 v[72:75], v[240:243], a[240:243], v[72:75]
  ds_read_b64_tr_b16 v[224:225], v48 offset:8192
  v_mfma_f32_16x16x32_bf16 v[76:79], v[240:243], a[244:247], v[76:79]
  ds_read_b64_tr_b16 v[226:227], v48 offset:9216
  s_waitcnt lgkmcnt(6)
  v_mfma_f32_16x16x32_bf16 v[88:91], v[244:247], a[240:243], v[88:91]
  ds_read_b64_tr_b16 v[228:229], v49 offset:8192
  v_mfma_f32_16x16x32_bf16 v[92:95], v[244:247], a[244:247], v[92:95]
  ds_read_b64_tr_b16 v[230:231], v49 offset:9216
  s_waitcnt lgkmcnt(6)
  v_mfma_f32_16x16x32_bf16 v[104:107], v[248:251], a[240:243], v[104:107]
  s_mov_b32 s78, 458752
  buffer_load_dwordx4 v[144:147], v27, s[28:31], s78 offen offset:0 sc1
  ds_read_b64_tr_b16 v[232:233], v50 offset:8192
  v_mfma_f32_16x16x32_bf16 v[108:111], v[248:251], a[244:247], v[108:111]
  ds_read_b64_tr_b16 v[234:235], v50 offset:9216
  s_waitcnt lgkmcnt(6)
  v_mfma_f32_16x16x32_bf16 v[120:123], v[252:255], a[240:243], v[120:123]
  ds_read_b64_tr_b16 v[236:237], v51 offset:8192
  v_mfma_f32_16x16x32_bf16 v[124:127], v[252:255], a[244:247], v[124:127]
  ds_read_b64_tr_b16 v[238:239], v51 offset:9216
  s_waitcnt vmcnt(19)
  s_mov_b32 s78, 466944
  buffer_load_dwordx4 v[148:151], v27, s[28:31], s78 offen offset:0 sc1
  s_waitcnt lgkmcnt(6)
  v_mfma_f32_16x16x32_bf16 v[72:75], v[224:227], a[248:251], v[72:75]
  ds_read_b64_tr_b16 v[240:241], v48 offset:12288
  v_mfma_f32_16x16x32_bf16 v[76:79], v[224:227], a[252:255], v[76:79]
  ds_read_b64_tr_b16 v[242:243], v48 offset:13312
  s_waitcnt lgkmcnt(6)
  v_mfma_f32_16x16x32_bf16 v[88:91], v[228:231], a[248:251], v[88:91]
  ds_read_b64_tr_b16 v[244:245], v49 offset:12288
  v_mfma_f32_16x16x32_bf16 v[92:95], v[228:231], a[252:255], v[92:95]
  ds_read_b64_tr_b16 v[246:247], v49 offset:13312
  s_waitcnt lgkmcnt(6)
  v_mfma_f32_16x16x32_bf16 v[104:107], v[232:235], a[248:251], v[104:107]
  s_mov_b32 s78, 475136
  buffer_load_dwordx4 v[152:155], v27, s[28:31], s78 offen offset:0 sc1
  ds_read_b64_tr_b16 v[248:249], v50 offset:12288
  v_mfma_f32_16x16x32_bf16 v[108:111], v[232:235], a[252:255], v[108:111]
  ds_read_b64_tr_b16 v[250:251], v50 offset:13312
  s_waitcnt lgkmcnt(6)
  v_mfma_f32_16x16x32_bf16 v[120:123], v[236:239], a[248:251], v[120:123]
  ds_read_b64_tr_b16 v[252:253], v51 offset:12288
  v_mfma_f32_16x16x32_bf16 v[124:127], v[236:239], a[252:255], v[124:127]
  ds_read_b64_tr_b16 v[254:255], v51 offset:13312
  s_mov_b32 s78, 483328
  buffer_load_dwordx4 v[156:159], v27, s[28:31], s78 offen offset:0 sc1
  s_mov_b32 s78, 491520
  buffer_load_dwordx4 v[160:163], v27, s[28:31], s78 offen offset:0 sc1
  s_mov_b32 s78, 499712
  buffer_load_dwordx4 v[164:167], v27, s[28:31], s78 offen offset:0 sc1
  s_mov_b32 s78, 507904
  buffer_load_dwordx4 v[168:171], v27, s[28:31], s78 offen offset:0 sc1
  s_waitcnt vmcnt(19)
  s_mov_b32 s78, 516096
  buffer_load_dwordx4 v[172:175], v27, s[28:31], s78 offen offset:0 sc1
  s_barrier
  s_waitcnt lgkmcnt(6)
  v_mfma_f32_16x16x32_bf16 v[72:75], v[240:243], a[176:179], v[72:75]
  ds_read_b64_tr_b16 v[224:225], v40 offset:0
  v_mfma_f32_16x16x32_bf16 v[76:79], v[240:243], a[180:183], v[76:79]
  s_mov_b32 s78, 524288
  buffer_load_dwordx4 v[176:179], v27, s[28:31], s78 offen offset:0 sc1
  ds_read_b64_tr_b16 v[226:227], v40 offset:1024
  s_waitcnt lgkmcnt(6)
  v_mfma_f32_16x16x32_bf16 v[88:91], v[244:247], a[176:179], v[88:91]
  ds_read_b64_tr_b16 v[228:229], v41 offset:0
  v_mfma_f32_16x16x32_bf16 v[92:95], v[244:247], a[180:183], v[92:95]
  ds_read_b64_tr_b16 v[230:231], v41 offset:1024
  s_waitcnt lgkmcnt(6)
  v_mfma_f32_16x16x32_bf16 v[104:107], v[248:251], a[176:179], v[104:107]
  ds_read_b64_tr_b16 v[232:233], v42 offset:0
  v_mfma_f32_16x16x32_bf16 v[108:111], v[248:251], a[180:183], v[108:111]
  s_mov_b32 s78, 532480
  buffer_load_dwordx4 v[180:183], v27, s[28:31], s78 offen offset:0 sc1
  ds_read_b64_tr_b16 v[234:235], v42 offset:1024
  s_waitcnt lgkmcnt(6)
  v_mfma_f32_16x16x32_bf16 v[120:123], v[252:255], a[176:179], v[120:123]
  ds_read_b64_tr_b16 v[236:237], v43 offset:0
  v_mfma_f32_16x16x32_bf16 v[124:127], v[252:255], a[180:183], v[124:127]
  ds_read_b64_tr_b16 v[238:239], v43 offset:1024
  s_waitcnt vmcnt(20)
  s_waitcnt lgkmcnt(6)
  v_mfma_f32_16x16x32_bf16 v[72:75], v[224:227], a[184:187], v[72:75]
  ds_read_b64_tr_b16 v[240:241], v40 offset:4096
  v_mfma_f32_16x16x32_bf16 v[76:79], v[224:227], a[188:191], v[76:79]
  s_mov_b32 s78, 540672
  buffer_load_dwordx4 v[184:187], v27, s[28:31], s78 offen offset:0 sc1
  ds_read_b64_tr_b16 v[242:243], v40 offset:5120
  s_waitcnt lgkmcnt(6)
  v_mfma_f32_16x16x32_bf16 v[88:91], v[228:231], a[184:187], v[88:91]
  ds_read_b64_tr_b16 v[244:245], v41 offset:4096
  v_mfma_f32_16x16x32_bf16 v[92:95], v[228:231], a[188:191], v[92:95]
  ds_read_b64_tr_b16 v[246:247], v41 offset:5120
  s_waitcnt lgkmcnt(6)
  v_mfma_f32_16x16x32_bf16 v[104:107], v[232:235], a[184:187], v[104:107]
  ds_read_b64_tr_b16 v[248:249], v42 offset:4096
  v_mfma_f32_16x16x32_bf16 v[108:111], v[232:235], a[188:191], v[108:111]
  s_mov_b32 s78, 548864
  buffer_load_dwordx4 v[188:191], v27, s[28:31], s78 offen offset:0 sc1
  ds_read_b64_tr_b16 v[250:251], v42 offset:5120
  s_waitcnt lgkmcnt(6)
  v_mfma_f32_16x16x32_bf16 v[120:123], v[236:239], a[184:187], v[120:123]
  ds_read_b64_tr_b16 v[252:253], v43 offset:4096
  v_mfma_f32_16x16x32_bf16 v[124:127], v[236:239], a[188:191], v[124:127]
  ds_read_b64_tr_b16 v[254:255], v43 offset:5120
  s_mov_b32 s78, 557056
  buffer_load_dwordx4 v[192:195], v27, s[28:31], s78 offen offset:0 sc1
  s_mov_b32 s78, 565248
  buffer_load_dwordx4 v[196:199], v27, s[28:31], s78 offen offset:0 sc1
  s_mov_b32 s78, 573440
  buffer_load_dwordx4 v[200:203], v27, s[28:31], s78 offen offset:0 sc1
  s_waitcnt vmcnt(19)
  s_mov_b32 s78, 581632
  buffer_load_dwordx4 v[204:207], v27, s[28:31], s78 offen offset:0 sc1
  s_waitcnt lgkmcnt(6)
  v_mfma_f32_16x16x32_bf16 v[72:75], v[240:243], a[192:195], v[72:75]
  ds_read_b64_tr_b16 v[224:225], v40 offset:8192
  v_mfma_f32_16x16x32_bf16 v[76:79], v[240:243], a[196:199], v[76:79]
  ds_read_b64_tr_b16 v[226:227], v40 offset:9216
  s_waitcnt lgkmcnt(6)
  v_mfma_f32_16x16x32_bf16 v[88:91], v[244:247], a[192:195], v[88:91]
  ds_read_b64_tr_b16 v[228:229], v41 offset:8192
  v_mfma_f32_16x16x32_bf16 v[92:95], v[244:247], a[196:199], v[92:95]
  ds_read_b64_tr_b16 v[230:231], v41 offset:9216
  s_waitcnt lgkmcnt(6)
  v_mfma_f32_16x16x32_bf16 v[104:107], v[248:251], a[192:195], v[104:107]
  ds_read_b64_tr_b16 v[232:233], v42 offset:8192
  v_mfma_f32_16x16x32_bf16 v[108:111], v[248:251], a[196:199], v[108:111]
  ds_read_b64_tr_b16 v[234:235], v42 offset:9216
  s_waitcnt lgkmcnt(6)
  v_mfma_f32_16x16x32_bf16 v[120:123], v[252:255], a[192:195], v[120:123]
  ds_read_b64_tr_b16 v[236:237], v43 offset:8192
  v_mfma_f32_16x16x32_bf16 v[124:127], v[252:255], a[196:199], v[124:127]
  ds_read_b64_tr_b16 v[238:239], v43 offset:9216
  s_waitcnt vmcnt(19)
  s_waitcnt lgkmcnt(6)
  v_mfma_f32_16x16x32_bf16 v[76:79], v[224:227], a[204:207], v[76:79]
  ds_read_b64_tr_b16 v[240:241], v40 offset:12288
  s_waitcnt lgkmcnt(5)
  v_mfma_f32_16x16x32_bf16 v[92:95], v[228:231], a[204:207], v[92:95]
  ds_read_b64_tr_b16 v[242:243], v40 offset:13312
  ds_read_b64_tr_b16 v[244:245], v41 offset:12288
  ds_read_b64_tr_b16 v[246:247], v41 offset:13312
  s_waitcnt lgkmcnt(6)
  v_mfma_f32_16x16x32_bf16 v[108:111], v[232:235], a[204:207], v[108:111]
  ds_read_b64_tr_b16 v[248:249], v42 offset:12288
  s_waitcnt lgkmcnt(5)
  v_mfma_f32_16x16x32_bf16 v[124:127], v[236:239], a[204:207], v[124:127]
  ds_read_b64_tr_b16 v[250:251], v42 offset:13312
  ds_read_b64_tr_b16 v[252:253], v43 offset:12288
  ds_read_b64_tr_b16 v[254:255], v43 offset:13312
  s_waitcnt vmcnt(18)
  s_waitcnt lgkmcnt(6)
  v_mfma_f32_16x16x32_bf16 v[76:79], v[240:243], a[212:215], v[76:79]
  ds_read_b64_tr_b16 v[224:225], v40 offset:8192
  s_waitcnt lgkmcnt(5)
  v_mfma_f32_16x16x32_bf16 v[92:95], v[244:247], a[212:215], v[92:95]
  ds_read_b64_tr_b16 v[226:227], v40 offset:9216
  ds_read_b64_tr_b16 v[228:229], v41 offset:8192
  ds_read_b64_tr_b16 v[230:231], v41 offset:9216
  s_waitcnt lgkmcnt(6)
  v_mfma_f32_16x16x32_bf16 v[108:111], v[248:251], a[212:215], v[108:111]
  ds_read_b64_tr_b16 v[232:233], v42 offset:8192
  s_waitcnt lgkmcnt(5)
  v_mfma_f32_16x16x32_bf16 v[124:127], v[252:255], a[212:215], v[124:127]
  ds_read_b64_tr_b16 v[234:235], v42 offset:9216
  ds_read_b64_tr_b16 v[236:237], v43 offset:8192
  ds_read_b64_tr_b16 v[238:239], v43 offset:9216
  v_perm_b32 v76, v213, v76, s3
  v_perm_b32 v77, v213, v77, s4
  buffer_store_dwordx4 v[76:79], v39, s[28:31], 0 offen offset:0 sc1
  v_perm_b32 v92, v213, v92, s3
  v_perm_b32 v93, v213, v93, s4
  v_perm_b32 v108, v213, v108, s3
  v_perm_b32 v109, v213, v109, s4
  v_perm_b32 v124, v213, v124, s3
  v_perm_b32 v125, v213, v125, s4
  buffer_store_dwordx4 v[92:95], v39, s[28:31], 0 offen offset:1024 sc1
  buffer_store_dwordx4 v[108:111], v39, s[28:31], 0 offen offset:2048 sc1
  buffer_store_dwordx4 v[124:127], v39, s[28:31], 0 offen offset:3072 sc1
  s_waitcnt vmcnt(21)
  s_waitcnt lgkmcnt(6)
  v_mfma_f32_16x16x32_bf16 v[72:75], v[224:227], a[200:203], v[72:75]
  ds_read_b64_tr_b16 v[240:241], v40 offset:12288
  s_waitcnt lgkmcnt(5)
  v_mfma_f32_16x16x32_bf16 v[88:91], v[228:231], a[200:203], v[88:91]
  ds_read_b64_tr_b16 v[242:243], v40 offset:13312
  ds_read_b64_tr_b16 v[244:245], v41 offset:12288
  ds_read_b64_tr_b16 v[246:247], v41 offset:13312
  s_waitcnt lgkmcnt(6)
  v_mfma_f32_16x16x32_bf16 v[104:107], v[232:235], a[200:203], v[104:107]
  ds_read_b64_tr_b16 v[248:249], v42 offset:12288
  s_waitcnt lgkmcnt(5)
  v_mfma_f32_16x16x32_bf16 v[120:123], v[236:239], a[200:203], v[120:123]
  ds_read_b64_tr_b16 v[250:251], v42 offset:13312
  ds_read_b64_tr_b16 v[252:253], v43 offset:12288
  ds_read_b64_tr_b16 v[254:255], v43 offset:13312
  s_waitcnt vmcnt(20)
  s_waitcnt lgkmcnt(6)
  v_mfma_f32_16x16x32_bf16 v[72:75], v[240:243], a[208:211], v[72:75]
  s_waitcnt lgkmcnt(4)
  v_mfma_f32_16x16x32_bf16 v[88:91], v[244:247], a[208:211], v[88:91]
  s_waitcnt lgkmcnt(2)
  v_mfma_f32_16x16x32_bf16 v[104:107], v[248:251], a[208:211], v[104:107]
  s_waitcnt lgkmcnt(0)
  v_mfma_f32_16x16x32_bf16 v[120:123], v[252:255], a[208:211], v[120:123]
  ds_read_b64_tr_b16 a[64:65], v40 offset:32768
  ds_read_b64_tr_b16 a[66:67], v40 offset:33792
  ds_read_b64_tr_b16 a[68:69], v41 offset:32768
  ds_read_b64_tr_b16 a[70:71], v41 offset:33792
  ds_read_b64_tr_b16 a[72:73], v42 offset:32768
  ds_read_b64_tr_b16 a[74:75], v42 offset:33792
  ds_read_b64_tr_b16 a[76:77], v43 offset:32768
  ds_read_b64_tr_b16 a[78:79], v43 offset:33792
  ds_read_b64_tr_b16 a[80:81], v40 offset:36864
  ds_read_b64_tr_b16 a[82:83], v40 offset:37888
  ds_read_b64_tr_b16 a[84:85], v41 offset:36864
  ds_read_b64_tr_b16 a[86:87], v41 offset:37888
  ds_read_b64_tr_b16 a[88:89], v42 offset:36864
  ds_read_b64_tr_b16 a[90:91], v42 offset:37888
  ds_read_b64_tr_b16 a[92:93], v43 offset:36864
  ds_read_b64_tr_b16 a[94:95], v43 offset:37888
  ds_read_b64_tr_b16 a[96:97], v40 offset:40960
  ds_read_b64_tr_b16 a[98:99], v40 offset:41984
  ds_read_b64_tr_b16 a[100:101], v41 offset:40960
  ds_read_b64_tr_b16 a[102:103], v41 offset:41984
  ds_read_b64_tr_b16 a[104:105], v42 offset:40960
  ds_read_b64_tr_b16 a[106:107], v42 offset:41984
  ds_read_b64_tr_b16 a[108:109], v43 offset:40960
  ds_read_b64_tr_b16 a[110:111], v43 offset:41984
  ds_read_b64_tr_b16 a[112:113], v40 offset:45056
  ds_read_b64_tr_b16 a[114:115], v40 offset:46080
  ds_read_b64_tr_b16 a[116:117], v41 offset:45056
  ds_read_b64_tr_b16 a[118:119], v41 offset:46080
  ds_read_b64_tr_b16 a[120:121], v42 offset:45056
  ds_read_b64_tr_b16 a[122:123], v42 offset:46080
  ds_read_b64_tr_b16 a[124:125], v43 offset:45056
  ds_read_b64_tr_b16 a[126:127], v43 offset:46080
  s_barrier
  ds_read_b64_tr_b16 a[128:129], v44 offset:0
  ds_read_b64_tr_b16 a[130:131], v44 offset:1024
  ds_read_b64_tr_b16 a[132:133], v45 offset:0
  ds_read_b64_tr_b16 a[134:135], v45 offset:1024
  ds_read_b64_tr_b16 a[136:137], v46 offset:0
  ds_read_b64_tr_b16 a[138:139], v46 offset:1024
  ds_read_b64_tr_b16 a[140:141], v47 offset:0
  ds_read_b64_tr_b16 a[142:143], v47 offset:1024
  s_waitcnt vmcnt(16)
L_chk3:
  v_xor_b32 v147, s69, v147
  v_xor_b32 v151, s69, v151
  v_xor_b32 v155, s69, v155
  v_xor_b32 v159, s69, v159
  v_or3_b32 v54, v147, v151, v155
  v_or_b32 v54, v54, v159
  v_cmp_lt_u32 vcc, s68, v54
  s_cmp_lg_u64 vcc, 0
  s_cbranch_scc1 L_spin3
L_ok3:
  v_mfma_f32_16x16x32_bf16 v[96:99], a[0:3], v[144:147], 0
  ds_read_b64_tr_b16 a[144:145], v44 offset:4096
  ds_read_b64_tr_b16 a[146:147], v44 offset:5120
  ds_read_b64_tr_b16 a[148:149], v45 offset:4096
  v_mfma_f32_16x16x32_bf16 v[100:103], a[4:7], v[144:147], 0
  ds_read_b64_tr_b16 a[150:151], v45 offset:5120
  ds_read_b64_tr_b16 a[152:153], v46 offset:4096
  ds_read_b64_tr_b16 a[154:155], v46 offset:5120
  v_mfma_f32_16x16x32_bf16 v[112:115], a[8:11], v[144:147], 0
  ds_read_b64_tr_b16 a[156:157], v47 offset:4096
  ds_read_b64_tr_b16 a[158:159], v47 offset:5120
  ds_read_b64_tr_b16 a[160:161], v44 offset:8192
  v_mfma_f32_16x16x32_bf16 v[116:119], a[12:15], v[144:147], 0
  ds_read_b64_tr_b16 a[162:163], v44 offset:9216
  ds_read_b64_tr_b16 a[164:165], v45 offset:8192
  ds_read_b64_tr_b16 a[166:167], v45 offset:9216
  v_mfma_f32_16x16x32_bf16 v[96:99], a[16:19], v[148:151], v[96:99]
  ds_read_b64_tr_b16 a[168:169], v46 offset:8192
  ds_read_b64_tr_b16 a[170:171], v46 offset:9216
  ds_read_b64_tr_b16 a[172:173], v47 offset:8192
  v_mfma_f32_16x16x32_bf16 v[100:103], a[20:23], v[148:151], v[100:103]
  ds_read_b64_tr_b16 a[174:175], v47 offset:9216
  ds_read_b64_tr_b16 a[176:177], v44 offset:12288
  ds_read_b64_tr_b16 a[178:179], v44 offset:13312
  v_mfma_f32_16x16x32_bf16 v[112:115], a[24:27], v[148:151], v[112:115]
  ds_read_b64_tr_b16 a[180:181], v45 offset:12288
  ds_read_b64_tr_b16 a[182:183], v45 offset:13312
  ds_read_b64_tr_b16 a[184:185], v46 offset:12288
  v_mfma_f32_16x16x32_bf16 v[116:119], a[28:31], v[148:151], v[116:119]
  ds_read_b64_tr_b16 a[186:187], v46 offset:13312
  ds_read_b64_tr_b16 a[188:189], v47 offset:12288
  ds_read_b64_tr_b16 a[190:191], v47 offset:13312
  v_mfma_f32_16x16x32_bf16 v[96:99], a[32:35], v[152:155], v[96:99]
  ds_read_b64_tr_b16 a[192:193], v44 offset:16384
  ds_read_b64_tr_b16 a[194:195], v44 offset:17408
  ds_read_b64_tr_b16 a[196:197], v45 offset:16384
  v_mfma_f32_16x16x32_bf16 v[100:103], a[36:39], v[152:155], v[100:103]
  ds_read_b64_tr_b16 a[198:199], v45 offset:17408
  ds_read_b64_tr_b16 a[200:201], v46 offset:16384
  ds_read_b64_tr_b16 a[202:203], v46 offset:17408
  v_mfma_f32_16x16x32_bf16 v[112:115], a[40:43], v[152:155], v[112:115]
  ds_read_b64_tr_b16 a[204:205], v47 offset:16384
  ds_read_b64_tr_b16 a[206:207], v47 offset:17408
  ds_read_b64_tr_b16 a[208:209], v44 offset:20480
  v_mfma_f32_16x16x32_bf16 v[116:119], a[44:47], v[152:155], v[116:119]
  ds_read_b64_tr_b16 a[210:211], v44 offset:21504
  ds_read_b64_tr_b16 a[212:213], v45 offset:20480
  buffer_load_dwordx4 v[64:67], v60, s[28:31], 0 offen offset:0 sc1
  ds_read_b64_tr_b16 a[214:215], v45 offset:21504
  v_mfma_f32_16x16x32_bf16 v[96:99], a[48:51], v[156:159], v[96:99]
  ds_read_b64_tr_b16 a[216:217], v46 offset:20480
  ds_read_b64_tr_b16 a[218:219], v46 offset:21504
  ds_read_b64_tr_b16 a[220:221], v47 offset:20480
  v_mfma_f32_16x16x32_bf16 v[100:103], a[52:55], v[156:159], v[100:103]
  ds_read_b64_tr_b16 a[222:223], v47 offset:21504
  ds_read_b64_tr_b16 a[224:225], v44 offset:24576
  ds_read_b64_tr_b16 a[226:227], v44 offset:25600
  v_mfma_f32_16x16x32_bf16 v[112:115], a[56:59], v[156:159], v[112:115]
  buffer_load_dwordx4 v[68:71], v60, s[28:31], 0 offen offset:1024 sc1
  ds_read_b64_tr_b16 a[228:229], v45 offset:24576
  ds_read_b64_tr_b16 a[230:231], v45 offset:25600
  ds_read_b64_tr_b16 a[232:233], v46 offset:24576
  v_mfma_f32_16x16x32_bf16 v[116:119], a[60:63], v[156:159], v[116:119]
  ds_read_b64_tr_b16 a[234:235], v46 offset:25600
  ds_read_b64_tr_b16 a[236:237], v47 offset:24576
  ds_read_b64_tr_b16 a[238:239], v47 offset:25600
  s_waitcnt vmcnt(14)
L_chk4:
  v_xor_b32 v163, s69, v163
  v_xor_b32 v167, s69, v167
  v_xor_b32 v171, s69, v171
  v_xor_b32 v175, s69, v175
  v_or3_b32 v54, v163, v167, v171
  v_or_b32 v54, v54, v175
  v_cmp_lt_u32 vcc, s68, v54
  s_cmp_lg_u64 vcc, 0
  s_cbranch_scc1 L_spin4
L_ok4:
  buffer_load_dwordx4 v[80:83], v60, s[28:31], 0 offen offset:2048 sc1
  s_waitcnt lgkmcnt(15)
  v_mfma_f32_16x16x32_bf16 v[96:99], a[64:67], v[160:163], v[96:99]
  ds_read_b64_tr_b16 a[240:241], v44 offset:28672
  ds_read_b64_tr_b16 a[242:243], v44 offset:29696
  ds_read_b64_tr_b16 a[244:245], v45 offset:28672
  s_waitcnt lgkmcnt(15)
  v_mfma_f32_16x16x32_bf16 v[100:103], a[68:71], v[160:163], v[100:103]
  ds_read_b64_tr_b16 a[246:247], v45 offset:29696
  ds_read_b64_tr_b16 a[248:249], v46 offset:28672
  ds_read_b64_tr_b16 a[250:251], v46 offset:29696
  s_waitcnt lgkmcnt(15)
  v_mfma_f32_16x16x32_bf16 v[112:115], a[72:75], v[160:163], v[112:115]
  ds_read_b64_tr_b16 a[252:253], v47 offset:28672
  buffer_load_dwordx4 v[84:87], v60, s[28:31], 0 offen offset:3072 sc1
  ds_read_b64_tr_b16 a[254:255], v47 offset:29696
  s_waitcnt lgkmcnt(15)
  v_mfma_f32_16x16x32_bf16 v[116:119], a[76:79], v[160:163], v[116:119]
  s_waitcnt lgkmcnt(15)
  v_mfma_f32_16x16x32_bf16 v[96:99], a[80:83], v[164:167], v[96:99]
  s_waitcnt lgkmcnt(15)
  v_mfma_f32_16x16x32_bf16 v[100:103], a[84:87], v[164:167], v[100:103]
  s_waitcnt lgkmcnt(15)
  v_mfma_f32_16x16x32_bf16 v[112:115], a[88:91], v[164:167], v[112:115]
  s_waitcnt lgkmcnt(15)
  v_mfma_f32_16x16x32_bf16 v[116:119], a[92:95], v[164:167], v[116:119]
  s_waitcnt lgkmcnt(15)
  v_mfma_f32_16x16x32_bf16 v[96:99], a[96:99], v[168:171], v[96:99]
  s_waitcnt lgkmcnt(15)
  v_mfma_f32_16x16x32_bf16 v[100:103], a[100:103], v[168:171], v[100:103]
  s_waitcnt lgkmcnt(15)
  v_mfma_f32_16x16x32_bf16 v[112:115], a[104:107], v[168:171], v[112:115]
  s_waitcnt lgkmcnt(15)
  v_mfma_f32_16x16x32_bf16 v[116:119], a[108:111], v[168:171], v[116:119]
  s_waitcnt lgkmcnt(15)
  v_mfma_f32_16x16x32_bf16 v[96:99], a[112:115], v[172:175], v[96:99]
  s_waitcnt lgkmcnt(15)
  v_mfma_f32_16x16x32_bf16 v[100:103], a[116:119], v[172:175], v[100:103]
  s_waitcnt lgkmcnt(15)
  v_mfma_f32_16x16x32_bf16 v[112:115], a[120:123], v[172:175], v[112:115]
  s_waitcnt lgkmcnt(15)
  v_mfma_f32_16x16x32_bf16 v[116:119], a[124:127], v[172:175], v[116:119]
  s_waitcnt vmcnt(12)
L_chk5:
  v_xor_b32 v179, s69, v179
  v_xor_b32 v183, s69, v183
  v_xor_b32 v187, s69, v187
  v_xor_b32 v191, s69, v191
  v_or3_b32 v54, v179, v183, v187
  v_or_b32 v54, v54, v191
  v_cmp_lt_u32 vcc, s68, v54
  s_cmp_lg_u64 vcc, 0
  s_cbranch_scc1 L_spin5
L_ok5:
  s_waitcnt lgkmcnt(15)
  v_mfma_f32_16x16x32_bf16 v[96:99], a[128:131], v[176:179], v[96:99]
  s_waitcnt lgkmcnt(15)
  v_mfma_f32_16x16x32_bf16 v[100:103], a[132:135], v[176:179], v[100:103]
  s_waitcnt lgkmcnt(15)
  v_mfma_f32_16x16x32_bf16 v[112:115], a[136:139], v[176:179], v[112:115]
  s_waitcnt lgkmcnt(15)
  v_mfma_f32_16x16x32_bf16 v[116:119], a[140:143], v[176:179], v[116:119]
  s_waitcnt lgkmcnt(15)
  v_mfma_f32_16x16x32_bf16 v[96:99], a[144:147], v[180:183], v[96:99]
  s_waitcnt lgkmcnt(15)
  v_mfma_f32_16x16x32_bf16 v[100:103], a[148:151], v[180:183], v[100:103]
  s_waitcnt lgkmcnt(15)
  v_mfma_f32_16x16x32_bf16 v[112:115], a[152:155], v[180:183], v[112:115]
  s_waitcnt lgkmcnt(15)
  v_mfma_f32_16x16x32_bf16 v[116:119], a[156:159], v[180:183], v[116:119]
  s_waitcnt lgkmcnt(15)
  v_mfma_f32_16x16x32_bf16 v[96:99], a[160:163], v[184:187], v[96:99]
  s_waitcnt lgkmcnt(15)
  v_mfma_f32_16x16x32_bf16 v[100:103], a[164:167], v[184:187], v[100:103]
  s_waitcnt lgkmcnt(15)
  v_mfma_f32_16x16x32_bf16 v[112:115], a[168:171], v[184:187], v[112:115]
  s_waitcnt lgkmcnt(15)
  v_mfma_f32_16x16x32_bf16 v[116:119], a[172:175], v[184:187], v[116:119]
  s_waitcnt lgkmcnt(15)
  v_mfma_f32_16x16x32_bf16 v[96:99], a[176:179], v[188:191], v[96:99]
  s_waitcnt lgkmcnt(15)
  v_mfma_f32_16x16x32_bf16 v[100:103], a[180:183], v[188:191], v[100:103]
  s_waitcnt lgkmcnt(15)
  v_mfma_f32_16x16x32_bf16 v[112:115], a[184:187], v[188:191], v[112:115]
  s_waitcnt lgkmcnt(15)
  v_mfma_f32_16x16x32_bf16 v[116:119], a[188:191], v[188:191], v[116:119]
  s_waitcnt vmcnt(8)
L_chk6:
  v_xor_b32 v195, s69, v195
  v_xor_b32 v199, s69, v199
  v_xor_b32 v203, s69, v203
  v_xor_b32 v207, s69, v207
  v_or3_b32 v54, v195, v199, v203
  v_or_b32 v54, v54, v207
  v_cmp_lt_u32 vcc, s68, v54
  s_cmp_lg_u64 vcc, 0
  s_cbranch_scc1 L_spin6
L_ok6:
  s_waitcnt lgkmcnt(15)
  v_mfma_f32_16x16x32_bf16 v[96:99], a[192:195], v[192:195], v[96:99]
  s_waitcnt lgkmcnt(15)
  v_mfma_f32_16x16x32_bf16 v[100:103], a[196:199], v[192:195], v[100:103]
  s_waitcnt lgkmcnt(15)
  v_mfma_f32_16x16x32_bf16 v[112:115], a[200:203], v[192:195], v[112:115]
  s_waitcnt lgkmcnt(15)
  v_mfma_f32_16x16x32_bf16 v[116:119], a[204:207], v[192:195], v[116:119]
  s_waitcnt lgkmcnt(15)
  v_mfma_f32_16x16x32_bf16 v[96:99], a[208:211], v[196:199], v[96:99]
  s_waitcnt lgkmcnt(15)
  v_mfma_f32_16x16x32_bf16 v[100:103], a[212:215], v[196:199], v[100:103]
  s_waitcnt lgkmcnt(15)
  v_mfma_f32_16x16x32_bf16 v[112:115], a[216:219], v[196:199], v[112:115]
  s_waitcnt lgkmcnt(15)
  v_mfma_f32_16x16x32_bf16 v[116:119], a[220:223], v[196:199], v[116:119]
  s_waitcnt lgkmcnt(14)
  v_mfma_f32_16x16x32_bf16 v[96:99], a[224:227], v[200:203], v[96:99]
  s_waitcnt lgkmcnt(12)
  v_mfma_f32_16x16x32_bf16 v[100:103], a[228:231], v[200:203], v[100:103]
  s_waitcnt lgkmcnt(10)
  v_mfma_f32_16x16x32_bf16 v[112:115], a[232:235], v[200:203], v[112:115]
  s_waitcnt lgkmcnt(8)
  v_mfma_f32_16x16x32_bf16 v[116:119], a[236:239], v[200:203], v[116:119]
  s_waitcnt lgkmcnt(6)
  v_mfma_f32_16x16x32_bf16 v[96:99], a[240:243], v[204:207], v[96:99]
  s_waitcnt lgkmcnt(4)
  v_mfma_f32_16x16x32_bf16 v[100:103], a[244:247], v[204:207], v[100:103]
  s_waitcnt lgkmcnt(2)
  v_mfma_f32_16x16x32_bf16 v[112:115], a[248:251], v[204:207], v[112:115]
  s_waitcnt lgkmcnt(0)
  v_mfma_f32_16x16x32_bf16 v[116:119], a[252:255], v[204:207], v[116:119]
  s_waitcnt vmcnt(0)
L_chk7:
  v_xor_b32 v64, s42, v64
  v_xor_b32 v65, s43, v65
  v_xor_b32 v68, s42, v68
  v_xor_b32 v69, s43, v69
  v_xor_b32 v80, s42, v80
  v_xor_b32 v81, s43, v81
  v_xor_b32 v84, s42, v84
  v_xor_b32 v85, s43, v85
  v_or3_b32 v54, v64, v65, v68
  v_or3_b32 v54, v54, v69, v80
  v_or3_b32 v54, v54, v81, v84
  v_or_b32 v54, v54, v85
  v_and_b32 v54, 0xff, v54
  v_cmp_ne_u32 vcc, 0, v54
  s_cmp_lg_u64 vcc, 0
  s_cbranch_scc1 L_spin7
L_ok7:
  v_pk_add_f32 v[72:73], v[72:73], v[64:65]
  v_pk_add_f32 v[74:75], v[74:75], v[66:67]
  v_pk_add_f32 v[88:89], v[88:89], v[68:69]
  v_pk_add_f32 v[90:91], v[90:91], v[70:71]
  v_pk_add_f32 v[104:105], v[104:105], v[80:81]
  v_pk_add_f32 v[106:107], v[106:107], v[82:83]
  v_pk_add_f32 v[120:121], v[120:121], v[84:85]
  v_pk_add_f32 v[122:123], v[122:123], v[86:87]
  v_pk_fma_f32 v[72:73], v[72:73], v[210:211], v[96:97] op_sel_hi:[1,0,1]
  v_pk_fma_f32 v[74:75], v[74:75], v[210:211], v[98:99] op_sel_hi:[1,0,1]
  v_cvt_pk_bf16_f32 v72, v72, v73
  v_cvt_pk_bf16_f32 v73, v74, v75
  buffer_store_dwordx2 v[72:73], v38, s[32:35], 0 offen offset:0
  v_pk_fma_f32 v[88:89], v[88:89], v[210:211], v[100:101] op_sel_hi:[1,0,1]
  v_pk_fma_f32 v[90:91], v[90:91], v[210:211], v[102:103] op_sel_hi:[1,0,1]
  v_cvt_pk_bf16_f32 v88, v88, v89
  v_cvt_pk_bf16_f32 v89, v90, v91
  buffer_store_dwordx2 v[88:89], v38, s[32:35], 0 offen offset:32
  v_pk_fma_f32 v[104:105], v[104:105], v[210:211], v[112:113] op_sel_hi:[1,0,1]
  v_pk_fma_f32 v[106:107], v[106:107], v[210:211], v[114:115] op_sel_hi:[1,0,1]
  v_cvt_pk_bf16_f32 v104, v104, v105
  v_cvt_pk_bf16_f32 v105, v106, v107
  buffer_store_dwordx2 v[104:105], v38, s[32:35], 0 offen offset:64
  v_pk_fma_f32 v[120:121], v[120:121], v[210:211], v[116:117] op_sel_hi:[1,0,1]
  v_pk_fma_f32 v[122:123], v[122:123], v[210:211], v[118:119] op_sel_hi:[1,0,1]
  v_cvt_pk_bf16_f32 v120, v120, v121
  v_cvt_pk_bf16_f32 v121, v122, v123
  buffer_store_dwordx2 v[120:121], v38, s[32:35], 0 offen offset:96
  s_cmp_lg_u32 s2, 0
  s_cbranch_scc1 L_fin
  v_mov_b32 v54, 0
  buffer_store_dwordx2 v[52:53], v54, s[28:31], 0 offen sc1
L_fin:
L_end:
  s_endpgm
L_idle:
  v_fma_f32 v2, v192, s62, v20
  v_fma_f32 v3, v193, s62, v20
  v_fma_f32 v4, v194, s62, v20
  v_fma_f32 v5, v195, s62, v20
  v_fma_f32 v6, v196, s62, v20
  v_fma_f32 v7, v197, s62, v20
  v_fma_f32 v8, v198, s62, v20
  v_fma_f32 v9, v199, s62, v20
  v_fma_f32 v10, v200, s62, v20
  v_fma_f32 v11, v201, s62, v20
  v_fma_f32 v12, v202, s62, v20
  v_fma_f32 v13, v203, s62, v20
  v_fma_f32 v14, v204, s62, v20
  v_fma_f32 v15, v205, s62, v20
  v_fma_f32 v16, v206, s62, v20
  v_fma_f32 v17, v207, s62, v20
  v_exp_f32_e64 v62, -v13
  v_exp_f32_e64 v63, -v17
  v_exp_f32_e64 v2, v2 clamp
  v_exp_f32_e64 v3, v3 clamp
  v_exp_f32_e64 v4, v4 clamp
  v_exp_f32_e64 v5, v5 clamp
  v_add_f32 v62, 1.0, v62
  v_add_f32 v63, 1.0, v63
  v_exp_f32_e64 v6, v6 clamp
  v_exp_f32_e64 v7, v7 clamp
  v_exp_f32_e64 v8, v8 clamp
  v_exp_f32_e64 v9, v9 clamp
  v_rcp_f32 v62, v62
  v_rcp_f32 v63, v63
  v_exp_f32_e64 v10, v10 clamp
  v_exp_f32_e64 v11, v11 clamp
  v_exp_f32_e64 v12, v12 clamp
  v_exp_f32_e64 v13, v13 clamp
  v_exp_f32_e64 v14, v14 clamp
  v_exp_f32_e64 v15, v15 clamp
  v_exp_f32_e64 v16, v16 clamp
  v_exp_f32_e64 v17, v17 clamp
  v_max_f32 v192, s64, v192
  v_max_f32 v193, s64, v193
  v_max_f32 v194, s64, v194
  v_max_f32 v195, s64, v195
  v_max_f32 v196, s64, v196
  v_max_f32 v197, s64, v197
  v_max_f32 v198, s64, v198
  v_max_f32 v199, s64, v199
  v_max_f32 v200, s64, v200
  v_max_f32 v201, s64, v201
  v_max_f32 v202, s64, v202
  v_max_f32 v203, s64, v203
  v_max_f32 v204, s64, v204
  v_max_f32 v205, s64, v205
  v_max_f32 v206, s64, v206
  v_max_f32 v207, s64, v207
  v_add_f32 v192, v192, v2
  v_add_f32 v193, v193, v3
  v_add_f32 v194, v194, v4
  v_add_f32 v195, v195, v5
  v_add_f32 v196, v196, v6
  v_add_f32 v197, v197, v7
  v_add_f32 v198, v198, v8
  v_add_f32 v199, v199, v9
  v_add_f32 v200, v200, v10
  v_add_f32 v201, v201, v11
  v_add_f32 v202, v202, v12
  v_add_f32 v203, v203, v13
  v_add_f32 v204, v204, v14
  v_add_f32 v205, v205, v15
  v_add_f32 v206, v206, v16
  v_add_f32 v207, v207, v17
  v_cvt_pk_bf16_f32 v192, v192, v193
  v_cvt_pk_bf16_f32 v193, v194, v195
  v_cvt_pk_bf16_f32 v194, v200, v201
  v_cvt_pk_bf16_f32 v195, v202, v203
  v_cvt_pk_bf16_f32 v196, v196, v197
  v_cvt_pk_bf16_f32 v197, v198, v199
  v_cvt_pk_bf16_f32 v198, v204, v205
  v_cvt_pk_bf16_f32 v199, v206, v207
  v_and_b32 v195, 0xffff, v195
  v_and_b32 v199, 0xffff, v199
  v_sub_f32 v210, 1.0, v62
  buffer_load_dwordx4 v[128:131], v56, s[28:31], 0 offen offset:0 sc1
  buffer_load_dwordx4 v[132:135], v56, s[28:31], 0 offen offset:1024 sc1
  buffer_load_dwordx4 v[136:139], v56, s[28:31], 0 offen offset:2048 sc1
  buffer_load_dwordx4 v[140:143], v56, s[28:31], 0 offen offset:3072 sc1
  s_movk_i32 s78, 4096
  buffer_load_dwordx4 v[144:147], v56, s[28:31], s78 offen offset:0 sc1
  buffer_load_dwordx4 v[148:151], v56, s[28:31], s78 offen offset:1024 sc1
  buffer_load_dwordx4 v[152:155], v56, s[28:31], s78 offen offset:2048 sc1
  buffer_load_dwordx4 v[156:159], v56, s[28:31], s78 offen offset:3072 sc1
  s_waitcnt vmcnt(4)
L_chk9:
  v_xor_b32 v131, s69, v131
  v_xor_b32 v135, s69, v135
  v_xor_b32 v139, s69, v139
  v_xor_b32 v143, s69, v143
  v_or3_b32 v54, v131, v135, v139
  v_or_b32 v54, v54, v143
  v_cmp_lt_u32 vcc, s68, v54
  s_cmp_lg_u64 vcc, 0
  s_cbranch_scc1 L_spin9
L_ok9:
  v_mfma_f32_16x16x32_bf16 v[160:163], v[218:221], v[128:131], 0
  v_mfma_f32_16x16x32_bf16 v[164:167], v[216:219], v[128:131], 0
  v_mfma_f32_16x16x32_bf16 v[160:163], v[218:221], v[132:135], v[160:163]
  v_mfma_f32_16x16x32_bf16 v[164:167], v[216:219], v[132:135], v[164:167]
  v_mfma_f32_16x16x32_bf16 v[160:163], v[218:221], v[136:139], v[160:163]
  v_mfma_f32_16x16x32_bf16 v[164:167], v[216:219], v[136:139], v[164:167]
  v_mfma_f32_16x16x32_bf16 v[160:163], v[218:221], v[140:143], v[160:163]
  v_mfma_f32_16x16x32_bf16 v[164:167], v[216:219], v[140:143], v[164:167]
  s_waitcnt vmcnt(0)
L_chk10:
  v_xor_b32 v147, s69, v147
  v_xor_b32 v151, s69, v151
  v_xor_b32 v155, s69, v155
  v_xor_b32 v159, s69, v159
  v_or3_b32 v54, v147, v151, v155
  v_or_b32 v54, v54, v159
  v_cmp_lt_u32 vcc, s68, v54
  s_cmp_lg_u64 vcc, 0
  s_cbranch_scc1 L_spin10
L_ok10:
  v_mfma_f32_16x16x32_bf16 v[160:163], v[218:221], v[144:147], v[160:163]
  v_mfma_f32_16x16x32_bf16 v[164:167], v[216:219], v[144:147], v[164:167]
  v_mfma_f32_16x16x32_bf16 v[160:163], v[218:221], v[148:151], v[160:163]
  v_mfma_f32_16x16x32_bf16 v[164:167], v[216:219], v[148:151], v[164:167]
  v_mfma_f32_16x16x32_bf16 v[160:163], v[218:221], v[152:155], v[160:163]
  v_mfma_f32_16x16x32_bf16 v[164:167], v[216:219], v[152:155], v[164:167]
  v_mfma_f32_16x16x32_bf16 v[160:163], v[218:221], v[156:159], v[160:163]
  v_mfma_f32_16x16x32_bf16 v[164:167], v[216:219], v[156:159], v[164:167]
  s_nop 6
  v_cvt_pk_bf16_f32 v160, v160, v161
  v_cvt_pk_bf16_f32 v161, v162, v163
  v_cvt_pk_bf16_f32 v162, v164, v165
  v_cvt_pk_bf16_f32 v163, v166, v167
  ds_write_b128 v59, v[160:163]
  s_waitcnt lgkmcnt(0)
  s_barrier
  ds_read_b128 v[168:171], v25 offset:28672
  ds_read_b128 v[172:175], v25 offset:29696
  ds_read_b128 v[176:179], v25 offset:30720
  ds_read_b128 v[180:183], v25 offset:31744
  s_waitcnt lgkmcnt(2)
  v_mfma_f32_16x16x32_bf16 v[132:135], v[172:175], v[192:195], 0
  v_mfma_f32_16x16x32_bf16 v[128:131], v[168:171], v[192:195], 0
  v_mfma_f32_16x16x32_bf16 v[140:143], v[172:175], v[196:199], 0
  v_mfma_f32_16x16x32_bf16 v[136:139], v[168:171], v[196:199], 0
  s_waitcnt lgkmcnt(0)
  v_mfma_f32_16x16x32_bf16 v[132:135], v[180:183], v[192:195], v[132:135]
  v_mfma_f32_16x16x32_bf16 v[128:131], v[176:179], v[192:195], v[128:131]
  v_mfma_f32_16x16x32_bf16 v[140:143], v[180:183], v[196:199], v[140:143]
  v_mfma_f32_16x16x32_bf16 v[136:139], v[176:179], v[196:199], v[136:139]
  s_nop 4
  v_add_f32 v2, s64, v135
  s_nop 0
  v_add_f32 v4, s64, v143
  v_rcp_f32 v2, v2
  v_rcp_f32 v4, v4
  v_mul_f32 v2, v2, v62
  v_mul_f32 v4, v4, v63
  v_mul_f32 v128, v128, v2
  v_mul_f32 v129, v129, v2
  v_mul_f32 v130, v130, v2
  v_mul_f32 v131, v131, v2
  v_mul_f32 v132, v132, v2
  v_mul_f32 v133, v133, v2
  v_mul_f32 v134, v134, v2
  v_mul_f32 v135, v135, v2
  v_cvt_pk_bf16_f32 v128, v128, v129
  v_cvt_pk_bf16_f32 v129, v130, v131
  v_cvt_pk_bf16_f32 v130, v132, v133
  v_cvt_pk_bf16_f32 v131, v134, v135
  v_and_or_b32 v131, v131, s68, v213
  buffer_store_dwordx4 v[128:131], v27, s[28:31], s74 offen offset:0 sc1
  v_mul_f32 v136, v136, v4
  v_mul_f32 v137, v137, v4
  v_mul_f32 v138, v138, v4
  v_mul_f32 v139, v139, v4
  v_mul_f32 v140, v140, v4
  v_mul_f32 v141, v141, v4
  v_mul_f32 v142, v142, v4
  v_mul_f32 v143, v143, v4
  v_cvt_pk_bf16_f32 v136, v136, v137
  v_cvt_pk_bf16_f32 v137, v138, v139
  v_cvt_pk_bf16_f32 v138, v140, v141
  v_cvt_pk_bf16_f32 v139, v142, v143
  v_and_or_b32 v139, v139, s68, v213
  buffer_store_dwordx4 v[136:139], v28, s[28:31], s74 offen offset:0 sc1
  s_endpgm
L_spin0:
  s_cmp_eq_u32 s53, 0
  s_cbranch_scc1 L_ok0
  s_sub_u32 s53, s53, 1
  buffer_load_dwordx2 v[222:223], v30, s[28:31], 0 offen sc1
  s_waitcnt vmcnt(0)
  s_branch L_chk0
L_spin1:
  s_cmp_eq_u32 s53, 0
  s_cbranch_scc1 L_ok1
  s_sub_u32 s53, s53, 1
  s_movk_i32 s82, 0
  buffer_load_dwordx4 v[128:131], v56, s[28:31], s82 offen offset:0 sc1
  buffer_load_dwordx4 v[132:135], v56, s[28:31], s82 offen offset:1024 sc1
  buffer_load_dwordx4 v[136:139], v56, s[28:31], s82 offen offset:2048 sc1
  buffer_load_dwordx4 v[140:143], v56, s[28:31], s82 offen offset:3072 sc1
  s_waitcnt vmcnt(0)
  s_branch L_chk1
L_spin2:
  s_cmp_eq_u32 s53, 0
  s_cbranch_scc1 L_ok2
  s_sub_u32 s53, s53, 1
  s_movk_i32 s82, 4096
  buffer_load_dwordx4 v[144:147], v56, s[28:31], s82 offen offset:0 sc1
  buffer_load_dwordx4 v[148:151], v56, s[28:31], s82 offen offset:1024 sc1
  buffer_load_dwordx4 v[152:155], v56, s[28:31], s82 offen offset:2048 sc1
  buffer_load_dwordx4 v[156:159], v56, s[28:31], s82 offen offset:3072 sc1
  s_waitcnt vmcnt(0)
  s_branch L_chk2
L_spin3:
  s_cmp_eq_u32 s53, 0
  s_cbranch_scc1 L_ok3
  s_sub_u32 s53, s53, 1
  s_mov_b32 s82, 458752
  buffer_load_dwordx4 v[144:147], v27, s[28:31], s82 offen offset:0 sc1
  s_mov_b32 s82, 466944
  buffer_load_dwordx4 v[148:151], v27, s[28:31], s82 offen offset:0 sc1
  s_mov_b32 s82, 475136
  buffer_load_dwordx4 v[152:155], v27, s[28:31], s82 offen offset:0 sc1
  s_mov_b32 s82, 483328
  buffer_load_dwordx4 v[156:159], v27, s[28:31], s82 offen offset:0 sc1
  s_waitcnt vmcnt(0)
  s_branch L_chk3
L_spin4:
  s_cmp_eq_u32 s53, 0
  s_cbranch_scc1 L_ok4
  s_sub_u32 s53, s53, 1
  s_mov_b32 s82, 491520
  buffer_load_dwordx4 v[160:163], v27, s[28:31], s82 offen offset:0 sc1
  s_mov_b32 s82, 499712
  buffer_load_dwordx4 v[164:167], v27, s[28:31], s82 offen offset:0 sc1
  s_mov_b32 s82, 507904
  buffer_load_dwordx4 v[168:171], v27, s[28:31], s82 offen offset:0 sc1
  s_mov_b32 s82, 516096
  buffer_load_dwordx4 v[172:175], v27, s[28:31], s82 offen offset:0 sc1
  s_waitcnt vmcnt(0)
  s_branch L_chk4
L_spin5:
  s_cmp_eq_u32 s53, 0
  s_cbranch_scc1 L_ok5
  s_sub_u32 s53, s53, 1
  s_mov_b32 s82, 524288
  buffer_load_dwordx4 v[176:179], v27, s[28:31], s82 offen offset:0 sc1
  s_mov_b32 s82, 532480
  buffer_load_dwordx4 v[180:183], v27, s[28:31], s82 offen offset:0 sc1
  s_mov_b32 s82, 540672
  buffer_load_dwordx4 v[184:187], v27, s[28:31], s82 offen offset:0 sc1
  s_mov_b32 s82, 548864
  buffer_load_dwordx4 v[188:191], v27, s[28:31], s82 offen offset:0 sc1
  s_waitcnt vmcnt(0)
  s_branch L_chk5
L_spin6:
  s_cmp_eq_u32 s53, 0
  s_cbranch_scc1 L_ok6
  s_sub_u32 s53, s53, 1
  s_mov_b32 s82, 557056
  buffer_load_dwordx4 v[192:195], v27, s[28:31], s82 offen offset:0 sc1
  s_mov_b32 s82, 565248
  buffer_load_dwordx4 v[196:199], v27, s[28:31], s82 offen offset:0 sc1
  s_mov_b32 s82, 573440
  buffer_load_dwordx4 v[200:203], v27, s[28:31], s82 offen offset:0 sc1
  s_mov_b32 s82, 581632
  buffer_load_dwordx4 v[204:207], v27, s[28:31], s82 offen offset:0 sc1
  s_waitcnt vmcnt(0)
  s_branch L_chk6
L_spin7:
  s_cmp_eq_u32 s53, 0
  s_cbranch_scc1 L_ok7
  s_sub_u32 s53, s53, 1
  buffer_load_dwordx4 v[64:67], v60, s[28:31], 0 offen offset:0 sc1
  buffer_load_dwordx4 v[68:71], v60, s[28:31], 0 offen offset:1024 sc1
  buffer_load_dwordx4 v[80:83], v60, s[28:31], 0 offen offset:2048 sc1
  buffer_load_dwordx4 v[84:87], v60, s[28:31], 0 offen offset:3072 sc1
  s_waitcnt vmcnt(0)
  s_branch L_chk7
L_spin8:
  s_cmp_eq_u32 s53, 0
  s_cbranch_scc1 L_ok8
  s_sub_u32 s53, s53, 1
  buffer_load_dwordx2 v[222:223], v31, s[28:31], 0 offen sc1
  s_waitcnt vmcnt(0)
  s_branch L_chk8
L_spin9:
  s_cmp_eq_u32 s53, 0
  s_cbranch_scc1 L_ok9
  s_sub_u32 s53, s53, 1
  s_movk_i32 s82, 0
  buffer_load_dwordx4 v[128:131], v56, s[28:31], s82 offen offset:0 sc1
  buffer_load_dwordx4 v[132:135], v56, s[28:31], s82 offen offset:1024 sc1
  buffer_load_dwordx4 v[136:139], v56, s[28:31], s82 offen offset:2048 sc1
  buffer_load_dwordx4 v[140:143], v56, s[28:31], s82 offen offset:3072 sc1
  s_waitcnt vmcnt(0)
  s_branch L_chk9
L_spin10:
  s_cmp_eq_u32 s53, 0
  s_cbranch_scc1 L_ok10
  s_sub_u32 s53, s53, 1
  s_movk_i32 s82, 4096
  buffer_load_dwordx4 v[144:147], v56, s[28:31], s82 offen offset:0 sc1
  buffer_load_dwordx4 v[148:151], v56, s[28:31], s82 offen offset:1024 sc1
  buffer_load_dwordx4 v[152:155], v56, s[28:31], s82 offen offset:2048 sc1
  buffer_load_dwordx4 v[156:159], v56, s[28:31], s82 offen offset:3072 sc1
  s_waitcnt vmcnt(0)
  s_branch L_chk10
L_codeend:
.section .rodata,"a"
.p2align 6
.amdhsa_kernel gated_mix__linear_attn_block__dense_activation_mish__prompt_kernel
  .amdhsa_next_free_vgpr 512
  .amdhsa_next_free_sgpr 102
  .amdhsa_accum_offset 256
  .amdhsa_group_segment_fixed_size 0
  .amdhsa_kernarg_size 88
  .amdhsa_user_sgpr_count 2
  .amdhsa_user_sgpr_kernarg_segment_ptr 1
  .amdhsa_system_sgpr_workgroup_id_x 1
.end_amdhsa_kernel
```
